```python
import torch

def _softmax(x, axis=-1):
    return torch.softmax(x, dim=axis)
def _gelu(x):
    return torch.nn.functional.gelu(x, approximate="tanh")
def _silu(x):
    return torch.nn.functional.silu(x)
def _sigmoid(x):
    return torch.sigmoid(x)
def _layernorm(x, axis=-1, eps=1e-5):
    m = x.mean(dim=axis, keepdim=True)
    v = x.var(dim=axis, keepdim=True, unbiased=False)
    return (x - m) / torch.sqrt(v + eps)
def _scatter_add(tgt, idx, src, axis=0):
    return tgt.clone().index_add_(axis, idx, src)
def _segment_sum(src, seg, n):
    out = torch.zeros((n,) + src.shape[1:], dtype=src.dtype)
    return out.index_add_(0, seg, src)
def _pad(x, pw):
    flat = tuple(v for pair in reversed(pw) for v in pair)
    return torch.nn.functional.pad(x, flat)

kernel_name = 'recurrent_scan__gqa_block_cached__swiglu_ffn__decode'

def setup_inputs():

    _w = (lambda a: (lambda t: t.to(torch.bfloat16) if t.is_floating_point() else t)(torch.as_tensor(a)))
    def _A_setup():
        B, Sq, D = 2, 1, 448
        Hq, Hkv, Sk, Dh = 16, 8, 32768, 256
        assert Hq % Hkv == 0, (Hq, Hkv)
        return {
            "x": _w((lambda *s: torch.randn(*s, dtype=torch.bfloat16) * 0.05)(B, Sq, D)),
            "k_cache": _w((lambda *s: torch.randn(*s, dtype=torch.bfloat16) * 0.8)(B, Hkv, Sk, Dh)),
            "v_cache": _w((lambda *s: torch.randn(*s, dtype=torch.bfloat16) * 0.8)(B, Hkv, Sk, Dh)),
            "wq": _w((lambda *s: torch.randn(*s, dtype=torch.bfloat16) * 0.8)(D, Hq * Dh) * (D ** -0.5)),
            "wo": _w((lambda *s: torch.randn(*s, dtype=torch.bfloat16) * 0.8)(Hq * Dh, D) * ((Hq * Dh) ** -0.5)),
        }
    _A_in = _A_setup()

    def _B_setup():
        B, S, D, F = 2, 1, 448, 1792
        return {
            "x": _w((lambda *s: torch.randn(*s, dtype=torch.bfloat16) * 0.05)(B, S, D)),
            "w_gate": _w((lambda *s: torch.randn(*s, dtype=torch.bfloat16) * 0.2)(D, F)),
            "w_up": _w((lambda *s: torch.randn(*s, dtype=torch.bfloat16) * 0.2)(D, F)),
            "w_down": _w((lambda *s: torch.randn(*s, dtype=torch.bfloat16) * 0.2)(F, D)),
        }
    _B_in = _B_setup()

    return {
        "A_x": _A_in["x"],
        "A_k_cache": _A_in["k_cache"],
        "A_v_cache": _A_in["v_cache"],
        "A_wq": _A_in["wq"],
        "A_wo": _A_in["wo"],
        "B_x": _B_in["x"],
        "B_w_gate": _B_in["w_gate"],
        "B_w_up": _B_in["w_up"],
        "B_w_down": _B_in["w_down"],
    }

def reference(A_x, A_k_cache, A_v_cache, A_wq, A_wo, B_x, B_w_gate, B_w_up, B_w_down):
    def _A_ref(x, k_cache, v_cache, wq, wo):
        B, Sq, D = x.shape
        Hq, Dh = 16, 256
        Hkv = k_cache.shape[1]
        rep = Hq // Hkv
        q = (lambda x, *d: x.permute(*d))((x @ wq).reshape(B, Sq, Hq, Dh), 0, 2, 1, 3)
        k = (lambda x, n, axis: torch.repeat_interleave(x, n, dim=axis))(k_cache, rep, axis=1)
        v = (lambda x, n, axis: torch.repeat_interleave(x, n, dim=axis))(v_cache, rep, axis=1)
        scores = torch.einsum("bhqd,bhkd->bhqk", q, k) * (Dh ** -0.5)
        p = _softmax(scores, axis=-1)
        o = torch.einsum("bhqk,bhkd->bhqd", p, v)
        return (lambda x, *d: x.permute(*d))(o, 0, 2, 1, 3).reshape(B, Sq, Hq * Dh) @ wo

    def _B_ref(x, w_gate, w_up, w_down):
        g = _silu(x @ w_gate)
        u = x @ w_up
        return (g * u) @ w_down

    x = A_x
    xn = _layernorm(x, axis=-1)
    s = _A_ref(xn, A_k_cache, A_v_cache, A_wq, A_wo)
    g = _silu(_B_ref(xn, B_w_gate, B_w_up, B_w_down))
    return x + s * g
```

```asm
; @launch grid=(256,1,1) block=(256,1,1) lds=162048
.amdgcn_target "amdgcn-amd-amdhsa--gfx950"
.text
.globl recurrent_scan__gqa_block_cached__swiglu_ffn__decode_kernel
.p2align 8
.type recurrent_scan__gqa_block_cached__swiglu_ffn__decode_kernel,@function
recurrent_scan__gqa_block_cached__swiglu_ffn__decode_kernel:
    s_cmp_ge_u32 s2, 256
    s_cbranch_scc1 L_end_recurren
    v_lshrrev_b32 v1, 6, v0
    v_and_b32 v0, 63, v0
    v_readfirstlane_b32 s3, v1
    s_mov_b32 s28, 0x400000
    s_and_b32 s98, s2, 15
    s_lshl_b32 s98, s98, 4
    s_lshr_b32 s99, s2, 4
    s_add_u32 s98, s98, s99
    s_cmp_eq_u32 s3, 2
    s_cbranch_scc0 L_n2_recurren
    v_lshlrev_b32 v2, 3, v0
    v_add_u32 v2, 0x27700, v2
    v_mov_b32 v4, 0
    v_mov_b32 v5, 0
    ds_write_b64 v2, v[4:5]
    s_waitcnt lgkmcnt(0)
    s_barrier
    s_branch L_w2_recurren
L_n2_recurren:
    s_load_dwordx16 s[4:19], s[0:1], 0
    s_load_dwordx8 s[20:27], s[0:1], 64
    s_cmp_eq_u32 s3, 1
    s_cbranch_scc1 L_w1_recurren
    s_cmp_eq_u32 s3, 3
    s_cbranch_scc1 L_w3_recurren
    s_setprio 3
    v_lshrrev_b32 v7, 3, v0
    v_lshlrev_b32 v1, 13, v7
    v_mul_u32_u24 v2, 3584, v7
    v_and_b32 v7, 7, v0
    v_lshl_add_u32 v1, v7, 4, v1
    v_lshl_add_u32 v2, v7, 4, v2
    v_lshrrev_b32 v7, 5, v0
    v_lshlrev_b32 v3, 13, v7
    v_and_b32 v7, 31, v0
    v_lshl_add_u32 v3, v7, 4, v3
    v_lshlrev_b32 v4, 2, v0
    v_add_u32 v4, 0x27700, v4
    v_mov_b32 v6, 0x27700
    v_mov_b32 v5, 0
    s_and_b32 s61, s2, 3
    s_lshr_b32 s62, s2, 2
    s_mul_i32 s56, s61, 0xe0000
    s_mul_i32 s29, s61, 0x62000
    s_lshl_b32 s61, s62, 7
    s_add_u32 s56, s56, s61
    s_add_u32 s29, s29, s61
    s_cmp_lt_u32 s62, 28
    s_cselect_b32 s30, 0, 3584
    s_sub_u32 s29, s29, s30
    s_cmp_lt_u32 s2, 224
    s_cselect_b32 s63, -1, 0
    v_and_b32 v2, s63, v2
    s_and_b32 s29, s29, s63
    s_lshr_b32 s61, s98, 4
    s_lshl_b32 s61, s61, 24
    s_barrier
    s_waitcnt lgkmcnt(0)
    s_mov_b32 s32, s10
    s_mov_b32 s33, s11
    s_mov_b32 s34, 0x380000
    s_mov_b32 s35, 0x20000
    s_mov_b32 m0, 0x20000
    s_nop 0
    buffer_load_dwordx4 v1, s[32:35], s56 offen nt lds
    s_add_u32 s56, s56, 0x10000
    s_add_u32 s44, s6, s61
    s_addc_u32 s45, s7, 0
    s_mov_b32 s46, 0x1000000
    s_mov_b32 s47, 0x20000
    s_mov_b32 m0, 0x20400
    s_nop 0
    buffer_load_dwordx4 v1, s[32:35], s56 offen nt lds
    s_add_u32 s56, s56, 0x10000
    s_add_u32 s48, s8, s61
    s_addc_u32 s49, s9, 0
    s_mov_b32 s50, 0x1000000
    s_mov_b32 s51, 0x20000
    s_mov_b32 m0, 0x20800
    s_nop 0
    buffer_load_dwordx4 v1, s[32:35], s56 offen nt lds
    s_add_u32 s56, s56, 0x10000
    s_cmp_eq_u32 s30, 0
    s_cselect_b32 s36, s16, s18
    s_cselect_b32 s37, s17, s19
    s_mov_b32 s38, 0x188000
    s_mov_b32 s39, 0x20000
    s_mov_b32 m0, 0x20c00
    s_nop 0
    buffer_load_dwordx4 v1, s[32:35], s56 offen nt lds
    s_add_u32 s56, s56, 0x10000
    s_mov_b32 m0, 0x21000
    s_nop 0
    buffer_load_dwordx4 v1, s[32:35], s56 offen nt lds
    s_add_u32 s56, s56, 0x10000
    s_mov_b32 m0, 0x21400
    s_nop 0
    buffer_load_dwordx4 v1, s[32:35], s56 offen nt lds
    s_add_u32 s56, s56, 0x10000
    s_mov_b32 m0, 0x21800
    s_nop 0
    buffer_load_dwordx4 v1, s[32:35], s56 offen nt lds
    s_add_u32 s56, s56, 0x10000
    s_mov_b32 m0, 0x21c00
    s_nop 0
    buffer_load_dwordx4 v1, s[32:35], s56 offen nt lds
    s_add_u32 s56, s56, 0x10000
    s_mov_b32 m0, 0x22000
    s_nop 0
    buffer_load_dwordx4 v1, s[32:35], s56 offen nt lds
    s_add_u32 s56, s56, 0x10000
    s_mov_b32 m0, 0x22400
    s_nop 0
    buffer_load_dwordx4 v1, s[32:35], s56 offen nt lds
    s_add_u32 s56, s56, 0x10000
    s_mov_b32 m0, 0x22800
    s_nop 0
    buffer_load_dwordx4 v1, s[32:35], s56 offen nt lds
    s_add_u32 s56, s56, 0x10000
    s_mov_b32 m0, 0x22c00
    s_nop 0
    buffer_load_dwordx4 v1, s[32:35], s56 offen nt lds
    s_add_u32 s56, s56, 0x10000
    s_mov_b32 m0, 0x23000
    s_nop 0
    buffer_load_dwordx4 v1, s[32:35], s56 offen nt lds
    s_add_u32 s56, s56, 0x10000
    s_mov_b32 m0, 0x23400
    s_nop 0
    buffer_load_dwordx4 v1, s[32:35], s56 offen nt lds
    s_add_u32 s56, s56, 0x10000
    s_and_b32 s31, s98, 15
    s_mov_b32 s59, 0
    s_xor_b32 s56, s31, s59
    s_and_b32 s56, s56, 15
    s_lshl_b32 s56, s56, 14
    s_and_b32 s57, s59, 63
    s_lshl_b32 s57, s57, 18
    s_add_u32 s56, s56, s57
    s_add_u32 s57, s56, 4096
    s_and_b32 s58, s59, 7
    s_lshl_b32 s58, s58, 14
    s_add_u32 m0, s58, 0
    s_nop 0
    buffer_load_dwordx4 v3, s[44:47], s56 offen offset:0 nt lds
    s_add_u32 m0, s58, 512
    s_nop 0
    buffer_load_dwordx4 v3, s[44:47], s56 offen offset:512 nt lds
    s_add_u32 m0, s58, 1024
    s_nop 0
    buffer_load_dwordx4 v3, s[44:47], s56 offen offset:1024 nt lds
    s_add_u32 m0, s58, 1536
    s_nop 0
    buffer_load_dwordx4 v3, s[44:47], s56 offen offset:1536 nt lds
    s_add_u32 m0, s58, 2048
    s_nop 0
    buffer_load_dwordx4 v3, s[44:47], s56 offen offset:2048 nt lds
    s_add_u32 m0, s58, 2560
    s_nop 0
    buffer_load_dwordx4 v3, s[44:47], s56 offen offset:2560 nt lds
    s_add_u32 m0, s58, 3072
    s_nop 0
    buffer_load_dwordx4 v3, s[44:47], s56 offen offset:3072 nt lds
    s_add_u32 m0, s58, 3584
    s_nop 0
    buffer_load_dwordx4 v3, s[44:47], s56 offen offset:3584 nt lds
    s_add_u32 m0, s58, 8192
    s_nop 0
    buffer_load_dwordx4 v3, s[44:47], s57 offen offset:0 nt lds
    s_add_u32 m0, s58, 8704
    s_nop 0
    buffer_load_dwordx4 v3, s[44:47], s57 offen offset:512 nt lds
    s_add_u32 m0, s58, 9216
    s_nop 0
    buffer_load_dwordx4 v3, s[44:47], s57 offen offset:1024 nt lds
    s_add_u32 m0, s58, 9728
    s_nop 0
    buffer_load_dwordx4 v3, s[44:47], s57 offen offset:1536 nt lds
    s_add_u32 m0, s58, 10240
    s_nop 0
    buffer_load_dwordx4 v3, s[44:47], s57 offen offset:2048 nt lds
    s_add_u32 m0, s58, 10752
    s_nop 0
    buffer_load_dwordx4 v3, s[44:47], s57 offen offset:2560 nt lds
    s_add_u32 m0, s58, 11264
    s_nop 0
    buffer_load_dwordx4 v3, s[44:47], s57 offen offset:3072 nt lds
    s_add_u32 m0, s58, 11776
    s_nop 0
    buffer_load_dwordx4 v3, s[44:47], s57 offen offset:3584 nt lds
    s_mov_b32 m0, 0x23800
    s_waitcnt vmcnt(21)
    buffer_load_dwordx4 v2, s[36:39], s29 offen nt lds
    s_add_u32 s29, s29, 0x7000
    s_mov_b32 m0, 0x23c00
    s_waitcnt vmcnt(21)
    buffer_load_dwordx4 v2, s[36:39], s29 offen nt lds
    s_add_u32 s29, s29, 0x7000
    s_mov_b32 m0, 0x24000
    s_waitcnt vmcnt(21)
    buffer_load_dwordx4 v2, s[36:39], s29 offen nt lds
    s_add_u32 s29, s29, 0x7000
    s_mov_b32 m0, 0x24400
    s_waitcnt vmcnt(21)
    buffer_load_dwordx4 v2, s[36:39], s29 offen nt lds
    s_add_u32 s29, s29, 0x7000
    s_mov_b32 m0, 0x24800
    s_waitcnt vmcnt(21)
    buffer_load_dwordx4 v2, s[36:39], s29 offen nt lds
    s_add_u32 s29, s29, 0x7000
    s_mov_b32 m0, 0x24c00
    s_waitcnt vmcnt(21)
    v_mov_b32 v5, 14
    ds_write_b32 v4, v5
    buffer_load_dwordx4 v2, s[36:39], s29 offen nt lds
    s_add_u32 s29, s29, 0x7000
    s_mov_b32 m0, 0x25000
    s_waitcnt vmcnt(21)
    buffer_load_dwordx4 v2, s[36:39], s29 offen nt lds
    s_add_u32 s29, s29, 0x7000
    s_mov_b32 m0, 0x25400
    s_waitcnt vmcnt(21)
    v_mov_b32 v5, 16
    ds_write_b32 v4, v5
    buffer_load_dwordx4 v2, s[36:39], s29 offen nt lds
    s_add_u32 s29, s29, 0x7000
    s_mov_b32 m0, 0x25800
    s_waitcnt vmcnt(21)
    buffer_load_dwordx4 v2, s[36:39], s29 offen nt lds
    s_add_u32 s29, s29, 0x7000
    s_mov_b32 m0, 0x25c00
    s_waitcnt vmcnt(21)
    buffer_load_dwordx4 v2, s[36:39], s29 offen nt lds
    s_add_u32 s29, s29, 0x7000
    s_mov_b32 m0, 0x26000
    s_waitcnt vmcnt(21)
    buffer_load_dwordx4 v2, s[36:39], s29 offen nt lds
    s_add_u32 s29, s29, 0x7000
    s_mov_b32 m0, 0x26400
    s_waitcnt vmcnt(21)
    v_mov_b32 v5, 20
    ds_write_b32 v4, v5
    buffer_load_dwordx4 v2, s[36:39], s29 offen nt lds
    s_add_u32 s29, s29, 0x7000
    s_mov_b32 m0, 0x26800
    s_waitcnt vmcnt(21)
    buffer_load_dwordx4 v2, s[36:39], s29 offen nt lds
    s_add_u32 s29, s29, 0x7000
    s_mov_b32 m0, 0x26c00
    s_waitcnt vmcnt(21)
    buffer_load_dwordx4 v2, s[36:39], s29 offen nt lds
    s_add_u32 s29, s29, 0x7000
    s_mov_b32 s59, 1
    s_xor_b32 s56, s31, s59
    s_and_b32 s56, s56, 15
    s_lshl_b32 s56, s56, 14
    s_and_b32 s57, s59, 63
    s_lshl_b32 s57, s57, 18
    s_add_u32 s56, s56, s57
    s_add_u32 s57, s56, 4096
    s_and_b32 s58, s59, 7
    s_lshl_b32 s58, s58, 14
    s_add_u32 m0, s58, 0
    s_waitcnt vmcnt(21)
    buffer_load_dwordx4 v3, s[44:47], s56 offen offset:0 nt lds
    s_add_u32 m0, s58, 512
    s_waitcnt vmcnt(21)
    v_mov_b32 v5, 24
    ds_write_b32 v4, v5
    buffer_load_dwordx4 v3, s[44:47], s56 offen offset:512 nt lds
    s_add_u32 m0, s58, 1024
    s_waitcnt vmcnt(21)
    buffer_load_dwordx4 v3, s[44:47], s56 offen offset:1024 nt lds
    s_add_u32 m0, s58, 1536
    s_waitcnt vmcnt(21)
    buffer_load_dwordx4 v3, s[44:47], s56 offen offset:1536 nt lds
    s_add_u32 m0, s58, 2048
    s_waitcnt vmcnt(21)
    buffer_load_dwordx4 v3, s[44:47], s56 offen offset:2048 nt lds
    s_add_u32 m0, s58, 2560
    s_waitcnt vmcnt(21)
    v_mov_b32 v5, 28
    ds_write_b32 v4, v5
    buffer_load_dwordx4 v3, s[44:47], s56 offen offset:2560 nt lds
    s_add_u32 m0, s58, 3072
    s_waitcnt vmcnt(21)
    buffer_load_dwordx4 v3, s[44:47], s56 offen offset:3072 nt lds
    s_add_u32 m0, s58, 3584
    s_waitcnt vmcnt(21)
    buffer_load_dwordx4 v3, s[44:47], s56 offen offset:3584 nt lds
    s_add_u32 m0, s58, 8192
    s_waitcnt vmcnt(21)
    buffer_load_dwordx4 v3, s[44:47], s57 offen offset:0 nt lds
    s_add_u32 m0, s58, 8704
    s_waitcnt vmcnt(21)
    v_mov_b32 v5, 32
    ds_write_b32 v4, v5
    buffer_load_dwordx4 v3, s[44:47], s57 offen offset:512 nt lds
    s_add_u32 m0, s58, 9216
    s_waitcnt vmcnt(21)
    buffer_load_dwordx4 v3, s[44:47], s57 offen offset:1024 nt lds
    s_add_u32 m0, s58, 9728
    s_waitcnt vmcnt(21)
    buffer_load_dwordx4 v3, s[44:47], s57 offen offset:1536 nt lds
    s_add_u32 m0, s58, 10240
    s_waitcnt vmcnt(21)
    buffer_load_dwordx4 v3, s[44:47], s57 offen offset:2048 nt lds
    s_add_u32 m0, s58, 10752
    s_waitcnt vmcnt(21)
    v_mov_b32 v5, 36
    ds_write_b32 v4, v5
    buffer_load_dwordx4 v3, s[44:47], s57 offen offset:2560 nt lds
    s_add_u32 m0, s58, 11264
    s_waitcnt vmcnt(21)
    buffer_load_dwordx4 v3, s[44:47], s57 offen offset:3072 nt lds
    s_add_u32 m0, s58, 11776
    s_waitcnt vmcnt(21)
    buffer_load_dwordx4 v3, s[44:47], s57 offen offset:3584 nt lds
    s_mov_b32 s59, 2
    s_xor_b32 s56, s31, s59
    s_and_b32 s56, s56, 15
    s_lshl_b32 s56, s56, 14
    s_and_b32 s57, s59, 63
    s_lshl_b32 s57, s57, 18
    s_add_u32 s56, s56, s57
    s_add_u32 s57, s56, 4096
    s_and_b32 s58, s59, 7
    s_lshl_b32 s58, s58, 14
    s_add_u32 m0, s58, 0
    s_waitcnt vmcnt(21)
    buffer_load_dwordx4 v3, s[44:47], s56 offen offset:0 nt lds
    s_add_u32 m0, s58, 512
    s_waitcnt vmcnt(21)
    v_mov_b32 v5, 40
    ds_write_b32 v4, v5
    buffer_load_dwordx4 v3, s[44:47], s56 offen offset:512 nt lds
    s_add_u32 m0, s58, 1024
    s_waitcnt vmcnt(21)
    buffer_load_dwordx4 v3, s[44:47], s56 offen offset:1024 nt lds
    s_add_u32 m0, s58, 1536
    s_waitcnt vmcnt(21)
    buffer_load_dwordx4 v3, s[44:47], s56 offen offset:1536 nt lds
    s_add_u32 m0, s58, 2048
    s_waitcnt vmcnt(21)
    buffer_load_dwordx4 v3, s[44:47], s56 offen offset:2048 nt lds
    s_add_u32 m0, s58, 2560
    s_waitcnt vmcnt(21)
    v_mov_b32 v5, 44
    ds_write_b32 v4, v5
    buffer_load_dwordx4 v3, s[44:47], s56 offen offset:2560 nt lds
    s_add_u32 m0, s58, 3072
    s_waitcnt vmcnt(21)
    buffer_load_dwordx4 v3, s[44:47], s56 offen offset:3072 nt lds
    s_add_u32 m0, s58, 3584
    s_waitcnt vmcnt(21)
    buffer_load_dwordx4 v3, s[44:47], s56 offen offset:3584 nt lds
    s_add_u32 m0, s58, 8192
    s_waitcnt vmcnt(21)
    buffer_load_dwordx4 v3, s[44:47], s57 offen offset:0 nt lds
    s_add_u32 m0, s58, 8704
    s_waitcnt vmcnt(21)
    v_mov_b32 v5, 48
    ds_write_b32 v4, v5
    buffer_load_dwordx4 v3, s[44:47], s57 offen offset:512 nt lds
    s_add_u32 m0, s58, 9216
    s_waitcnt vmcnt(21)
    buffer_load_dwordx4 v3, s[44:47], s57 offen offset:1024 nt lds
    s_add_u32 m0, s58, 9728
    s_waitcnt vmcnt(21)
    buffer_load_dwordx4 v3, s[44:47], s57 offen offset:1536 nt lds
    s_add_u32 m0, s58, 10240
    s_waitcnt vmcnt(21)
    buffer_load_dwordx4 v3, s[44:47], s57 offen offset:2048 nt lds
    s_add_u32 m0, s58, 10752
    s_waitcnt vmcnt(21)
    v_mov_b32 v5, 52
    ds_write_b32 v4, v5
    buffer_load_dwordx4 v3, s[44:47], s57 offen offset:2560 nt lds
    s_add_u32 m0, s58, 11264
    s_waitcnt vmcnt(21)
    buffer_load_dwordx4 v3, s[44:47], s57 offen offset:3072 nt lds
    s_add_u32 m0, s58, 11776
    s_waitcnt vmcnt(21)
    buffer_load_dwordx4 v3, s[44:47], s57 offen offset:3584 nt lds
    s_mov_b32 s59, 3
    s_xor_b32 s56, s31, s59
    s_and_b32 s56, s56, 15
    s_lshl_b32 s56, s56, 14
    s_and_b32 s57, s59, 63
    s_lshl_b32 s57, s57, 18
    s_add_u32 s56, s56, s57
    s_add_u32 s57, s56, 4096
    s_and_b32 s58, s59, 7
    s_lshl_b32 s58, s58, 14
    s_add_u32 m0, s58, 0
    s_waitcnt vmcnt(21)
    buffer_load_dwordx4 v3, s[44:47], s56 offen offset:0 nt lds
    s_add_u32 m0, s58, 512
    s_waitcnt vmcnt(21)
    v_mov_b32 v5, 56
    ds_write_b32 v4, v5
    buffer_load_dwordx4 v3, s[44:47], s56 offen offset:512 nt lds
    s_add_u32 m0, s58, 1024
    s_waitcnt vmcnt(21)
    buffer_load_dwordx4 v3, s[44:47], s56 offen offset:1024 nt lds
    s_add_u32 m0, s58, 1536
    s_waitcnt vmcnt(21)
    buffer_load_dwordx4 v3, s[44:47], s56 offen offset:1536 nt lds
    s_add_u32 m0, s58, 2048
    s_waitcnt vmcnt(21)
    buffer_load_dwordx4 v3, s[44:47], s56 offen offset:2048 nt lds
    s_add_u32 m0, s58, 2560
    s_waitcnt vmcnt(21)
    v_mov_b32 v5, 60
    ds_write_b32 v4, v5
    buffer_load_dwordx4 v3, s[44:47], s56 offen offset:2560 nt lds
    s_add_u32 m0, s58, 3072
    s_waitcnt vmcnt(21)
    buffer_load_dwordx4 v3, s[44:47], s56 offen offset:3072 nt lds
    s_add_u32 m0, s58, 3584
    s_waitcnt vmcnt(21)
    v_mov_b32 v5, 62
    ds_write_b32 v4, v5
    buffer_load_dwordx4 v3, s[44:47], s56 offen offset:3584 nt lds
    s_add_u32 m0, s58, 8192
    s_waitcnt vmcnt(21)
    buffer_load_dwordx4 v3, s[44:47], s57 offen offset:0 nt lds
    s_add_u32 m0, s58, 8704
    s_waitcnt vmcnt(21)
    buffer_load_dwordx4 v3, s[44:47], s57 offen offset:512 nt lds
    s_add_u32 m0, s58, 9216
    s_waitcnt vmcnt(21)
    buffer_load_dwordx4 v3, s[44:47], s57 offen offset:1024 nt lds
    s_add_u32 m0, s58, 9728
    s_waitcnt vmcnt(21)
    buffer_load_dwordx4 v3, s[44:47], s57 offen offset:1536 nt lds
    s_add_u32 m0, s58, 10240
    s_waitcnt vmcnt(21)
    buffer_load_dwordx4 v3, s[44:47], s57 offen offset:2048 nt lds
    s_add_u32 m0, s58, 10752
    s_waitcnt vmcnt(21)
    buffer_load_dwordx4 v3, s[44:47], s57 offen offset:2560 nt lds
    s_add_u32 m0, s58, 11264
    s_waitcnt vmcnt(21)
    buffer_load_dwordx4 v3, s[44:47], s57 offen offset:3072 nt lds
    s_add_u32 m0, s58, 11776
    s_waitcnt vmcnt(21)
    buffer_load_dwordx4 v3, s[44:47], s57 offen offset:3584 nt lds
    s_mov_b32 s59, 4
    v_mov_b32 v8, 0
    v_mov_b32 v9, 0
    v_mov_b32 v10, 0
.p2align 6
L_ldk_recurren:
    s_xor_b32 s56, s31, s59
    s_and_b32 s56, s56, 15
    s_lshl_b32 s56, s56, 14
    s_and_b32 s57, s59, 63
    s_lshl_b32 s57, s57, 18
    s_add_u32 s56, s56, s57
    s_add_u32 s57, s56, 4096
    s_and_b32 s58, s59, 7
    s_lshl_b32 s58, s58, 14
    s_sub_u32 s63, s59, 6
    s_ashr_i32 s63, s63, 1
L_chkk_recurren:
    s_waitcnt lgkmcnt(0)
    v_readfirstlane_b32 s60, v8
    v_readfirstlane_b32 s61, v9
    v_readfirstlane_b32 s40, v10
    s_bitcmp1_b32 s59, 0
    s_cselect_b32 s60, s61, s60
    s_xor_b32 s40, s40, 0x1111
    ds_read_b96 v[8:10], v6 offset:256
    s_cmp_ge_i32 s60, s63
    s_cbranch_scc1 L_gok_recurren
    s_sub_u32 s28, s28, 1
    s_cmp_gt_i32 s28, 0
    s_cbranch_scc1 L_chkk_recurren
L_gok_recurren:
    s_add_u32 m0, s58, 0
    s_bitcmp1_b32 s40, 0
    s_cbranch_scc0 L_w0k_recurren
    s_waitcnt vmcnt(19)
L_w0k_recurren:
    s_waitcnt vmcnt(29)
    buffer_load_dwordx4 v3, s[44:47], s56 offen offset:0 nt lds
    s_add_u32 m0, s58, 512
    s_bitcmp1_b32 s40, 1
    s_cbranch_scc0 L_w1k_recurren
    s_waitcnt vmcnt(19)
L_w1k_recurren:
    s_waitcnt vmcnt(29)
    buffer_load_dwordx4 v3, s[44:47], s56 offen offset:512 nt lds
    s_add_u32 m0, s58, 1024
    s_bitcmp1_b32 s40, 2
    s_cbranch_scc0 L_w2k_recurren
    s_waitcnt vmcnt(19)
L_w2k_recurren:
    s_waitcnt vmcnt(29)
    buffer_load_dwordx4 v3, s[44:47], s56 offen offset:1024 nt lds
    s_add_u32 m0, s58, 1536
    s_bitcmp1_b32 s40, 3
    s_cbranch_scc0 L_w3k_recurren
    s_waitcnt vmcnt(19)
L_w3k_recurren:
    s_waitcnt vmcnt(29)
    buffer_load_dwordx4 v3, s[44:47], s56 offen offset:1536 nt lds
    v_add_u32 v5, 4, v5
    ds_write_b32 v4, v5
    s_add_u32 m0, s58, 2048
    s_bitcmp1_b32 s40, 4
    s_cbranch_scc0 L_w4k_recurren
    s_waitcnt vmcnt(19)
L_w4k_recurren:
    s_waitcnt vmcnt(29)
    buffer_load_dwordx4 v3, s[44:47], s56 offen offset:2048 nt lds
    s_add_u32 m0, s58, 2560
    s_bitcmp1_b32 s40, 5
    s_cbranch_scc0 L_w5k_recurren
    s_waitcnt vmcnt(19)
L_w5k_recurren:
    s_waitcnt vmcnt(29)
    buffer_load_dwordx4 v3, s[44:47], s56 offen offset:2560 nt lds
    s_add_u32 m0, s58, 3072
    s_bitcmp1_b32 s40, 6
    s_cbranch_scc0 L_w6k_recurren
    s_waitcnt vmcnt(19)
L_w6k_recurren:
    s_waitcnt vmcnt(29)
    buffer_load_dwordx4 v3, s[44:47], s56 offen offset:3072 nt lds
    s_add_u32 m0, s58, 3584
    s_bitcmp1_b32 s40, 7
    s_cbranch_scc0 L_w7k_recurren
    s_waitcnt vmcnt(19)
L_w7k_recurren:
    s_waitcnt vmcnt(29)
    buffer_load_dwordx4 v3, s[44:47], s56 offen offset:3584 nt lds
    v_add_u32 v5, 4, v5
    ds_write_b32 v4, v5
    s_add_u32 m0, s58, 8192
    s_bitcmp1_b32 s40, 8
    s_cbranch_scc0 L_w8k_recurren
    s_waitcnt vmcnt(19)
L_w8k_recurren:
    s_waitcnt vmcnt(29)
    buffer_load_dwordx4 v3, s[44:47], s57 offen offset:0 nt lds
    s_add_u32 m0, s58, 8704
    s_bitcmp1_b32 s40, 9
    s_cbranch_scc0 L_w9k_recurren
    s_waitcnt vmcnt(19)
L_w9k_recurren:
    s_waitcnt vmcnt(29)
    buffer_load_dwordx4 v3, s[44:47], s57 offen offset:512 nt lds
    s_add_u32 m0, s58, 9216
    s_bitcmp1_b32 s40, 10
    s_cbranch_scc0 L_w10k_recurren
    s_waitcnt vmcnt(19)
L_w10k_recurren:
    s_waitcnt vmcnt(29)
    buffer_load_dwordx4 v3, s[44:47], s57 offen offset:1024 nt lds
    s_add_u32 m0, s58, 9728
    s_bitcmp1_b32 s40, 11
    s_cbranch_scc0 L_w11k_recurren
    s_waitcnt vmcnt(19)
L_w11k_recurren:
    s_waitcnt vmcnt(29)
    buffer_load_dwordx4 v3, s[44:47], s57 offen offset:1536 nt lds
    v_add_u32 v5, 4, v5
    ds_write_b32 v4, v5
    s_add_u32 m0, s58, 10240
    s_bitcmp1_b32 s40, 12
    s_cbranch_scc0 L_w12k_recurren
    s_waitcnt vmcnt(19)
L_w12k_recurren:
    s_waitcnt vmcnt(29)
    buffer_load_dwordx4 v3, s[44:47], s57 offen offset:2048 nt lds
    s_add_u32 m0, s58, 10752
    s_bitcmp1_b32 s40, 13
    s_cbranch_scc0 L_w13k_recurren
    s_waitcnt vmcnt(19)
L_w13k_recurren:
    s_waitcnt vmcnt(29)
    buffer_load_dwordx4 v3, s[44:47], s57 offen offset:2560 nt lds
    s_add_u32 m0, s58, 11264
    s_bitcmp1_b32 s40, 14
    s_cbranch_scc0 L_w14k_recurren
    s_waitcnt vmcnt(19)
L_w14k_recurren:
    s_waitcnt vmcnt(29)
    buffer_load_dwordx4 v3, s[44:47], s57 offen offset:3072 nt lds
    s_add_u32 m0, s58, 11776
    s_bitcmp1_b32 s40, 15
    s_cbranch_scc0 L_w15k_recurren
    s_waitcnt vmcnt(19)
L_w15k_recurren:
    s_waitcnt vmcnt(29)
    buffer_load_dwordx4 v3, s[44:47], s57 offen offset:3584 nt lds
    v_add_u32 v5, 4, v5
    ds_write_b32 v4, v5
    s_add_u32 s59, s59, 1
    s_cmp_lt_u32 s59, 64
    s_cbranch_scc1 L_ldk_recurren
.p2align 6
L_ldv_recurren:
    s_xor_b32 s56, s31, s59
    s_and_b32 s56, s56, 15
    s_lshl_b32 s56, s56, 14
    s_and_b32 s57, s59, 63
    s_lshl_b32 s57, s57, 18
    s_add_u32 s56, s56, s57
    s_add_u32 s57, s56, 4096
    s_and_b32 s58, s59, 7
    s_lshl_b32 s58, s58, 14
    s_sub_u32 s63, s59, 6
    s_ashr_i32 s63, s63, 1
L_chkv_recurren:
    s_waitcnt lgkmcnt(0)
    v_readfirstlane_b32 s60, v8
    v_readfirstlane_b32 s61, v9
    v_readfirstlane_b32 s40, v10
    s_bitcmp1_b32 s59, 0
    s_cselect_b32 s60, s61, s60
    s_xor_b32 s40, s40, 0x1111
    ds_read_b96 v[8:10], v6 offset:256
    s_cmp_ge_i32 s60, s63
    s_cbranch_scc1 L_gov_recurren
    s_sub_u32 s28, s28, 1
    s_cmp_gt_i32 s28, 0
    s_cbranch_scc1 L_chkv_recurren
L_gov_recurren:
    s_add_u32 m0, s58, 0
    s_bitcmp1_b32 s40, 0
    s_cbranch_scc0 L_w0v_recurren
    s_waitcnt vmcnt(19)
L_w0v_recurren:
    s_waitcnt vmcnt(29)
    buffer_load_dwordx4 v3, s[48:51], s56 offen offset:0 nt lds
    s_add_u32 m0, s58, 512
    s_bitcmp1_b32 s40, 1
    s_cbranch_scc0 L_w1v_recurren
    s_waitcnt vmcnt(19)
L_w1v_recurren:
    s_waitcnt vmcnt(29)
    buffer_load_dwordx4 v3, s[48:51], s56 offen offset:512 nt lds
    s_add_u32 m0, s58, 1024
    s_bitcmp1_b32 s40, 2
    s_cbranch_scc0 L_w2v_recurren
    s_waitcnt vmcnt(19)
L_w2v_recurren:
    s_waitcnt vmcnt(29)
    buffer_load_dwordx4 v3, s[48:51], s56 offen offset:1024 nt lds
    s_add_u32 m0, s58, 1536
    s_bitcmp1_b32 s40, 3
    s_cbranch_scc0 L_w3v_recurren
    s_waitcnt vmcnt(19)
L_w3v_recurren:
    s_waitcnt vmcnt(29)
    buffer_load_dwordx4 v3, s[48:51], s56 offen offset:1536 nt lds
    v_add_u32 v5, 4, v5
    ds_write_b32 v4, v5
    s_add_u32 m0, s58, 2048
    s_bitcmp1_b32 s40, 4
    s_cbranch_scc0 L_w4v_recurren
    s_waitcnt vmcnt(19)
L_w4v_recurren:
    s_waitcnt vmcnt(29)
    buffer_load_dwordx4 v3, s[48:51], s56 offen offset:2048 nt lds
    s_add_u32 m0, s58, 2560
    s_bitcmp1_b32 s40, 5
    s_cbranch_scc0 L_w5v_recurren
    s_waitcnt vmcnt(19)
L_w5v_recurren:
    s_waitcnt vmcnt(29)
    buffer_load_dwordx4 v3, s[48:51], s56 offen offset:2560 nt lds
    s_add_u32 m0, s58, 3072
    s_bitcmp1_b32 s40, 6
    s_cbranch_scc0 L_w6v_recurren
    s_waitcnt vmcnt(19)
L_w6v_recurren:
    s_waitcnt vmcnt(29)
    buffer_load_dwordx4 v3, s[48:51], s56 offen offset:3072 nt lds
    s_add_u32 m0, s58, 3584
    s_bitcmp1_b32 s40, 7
    s_cbranch_scc0 L_w7v_recurren
    s_waitcnt vmcnt(19)
L_w7v_recurren:
    s_waitcnt vmcnt(29)
    buffer_load_dwordx4 v3, s[48:51], s56 offen offset:3584 nt lds
    v_add_u32 v5, 4, v5
    ds_write_b32 v4, v5
    s_add_u32 m0, s58, 8192
    s_bitcmp1_b32 s40, 8
    s_cbranch_scc0 L_w8v_recurren
    s_waitcnt vmcnt(19)
L_w8v_recurren:
    s_waitcnt vmcnt(29)
    buffer_load_dwordx4 v3, s[48:51], s57 offen offset:0 nt lds
    s_add_u32 m0, s58, 8704
    s_bitcmp1_b32 s40, 9
    s_cbranch_scc0 L_w9v_recurren
    s_waitcnt vmcnt(19)
L_w9v_recurren:
    s_waitcnt vmcnt(29)
    buffer_load_dwordx4 v3, s[48:51], s57 offen offset:512 nt lds
    s_add_u32 m0, s58, 9216
    s_bitcmp1_b32 s40, 10
    s_cbranch_scc0 L_w10v_recurren
    s_waitcnt vmcnt(19)
L_w10v_recurren:
    s_waitcnt vmcnt(29)
    buffer_load_dwordx4 v3, s[48:51], s57 offen offset:1024 nt lds
    s_add_u32 m0, s58, 9728
    s_bitcmp1_b32 s40, 11
    s_cbranch_scc0 L_w11v_recurren
    s_waitcnt vmcnt(19)
L_w11v_recurren:
    s_waitcnt vmcnt(29)
    buffer_load_dwordx4 v3, s[48:51], s57 offen offset:1536 nt lds
    v_add_u32 v5, 4, v5
    ds_write_b32 v4, v5
    s_add_u32 m0, s58, 10240
    s_bitcmp1_b32 s40, 12
    s_cbranch_scc0 L_w12v_recurren
    s_waitcnt vmcnt(19)
L_w12v_recurren:
    s_waitcnt vmcnt(29)
    buffer_load_dwordx4 v3, s[48:51], s57 offen offset:2048 nt lds
    s_add_u32 m0, s58, 10752
    s_bitcmp1_b32 s40, 13
    s_cbranch_scc0 L_w13v_recurren
    s_waitcnt vmcnt(19)
L_w13v_recurren:
    s_waitcnt vmcnt(29)
    buffer_load_dwordx4 v3, s[48:51], s57 offen offset:2560 nt lds
    s_add_u32 m0, s58, 11264
    s_bitcmp1_b32 s40, 14
    s_cbranch_scc0 L_w14v_recurren
    s_waitcnt vmcnt(19)
L_w14v_recurren:
    s_waitcnt vmcnt(29)
    buffer_load_dwordx4 v3, s[48:51], s57 offen offset:3072 nt lds
    s_add_u32 m0, s58, 11776
    s_bitcmp1_b32 s40, 15
    s_cbranch_scc0 L_w15v_recurren
    s_waitcnt vmcnt(19)
L_w15v_recurren:
    s_waitcnt vmcnt(29)
    buffer_load_dwordx4 v3, s[48:51], s57 offen offset:3584 nt lds
    v_add_u32 v5, 4, v5
    ds_write_b32 v4, v5
    s_add_u32 s59, s59, 1
    s_cmp_lt_u32 s59, 122
    s_cbranch_scc1 L_ldv_recurren
    s_xor_b32 s56, s31, s59
    s_and_b32 s56, s56, 15
    s_lshl_b32 s56, s56, 14
    s_and_b32 s57, s59, 63
    s_lshl_b32 s57, s57, 18
    s_add_u32 s56, s56, s57
    s_add_u32 s57, s56, 4096
    s_and_b32 s58, s59, 7
    s_lshl_b32 s58, s58, 14
    s_sub_u32 s63, s59, 6
    s_ashr_i32 s63, s63, 1
L_chkb0_recurren:
    s_waitcnt lgkmcnt(0)
    v_readfirstlane_b32 s60, v8
    v_readfirstlane_b32 s61, v9
    v_readfirstlane_b32 s40, v10
    s_bitcmp1_b32 s59, 0
    s_cselect_b32 s60, s61, s60
    s_xor_b32 s40, s40, 0x1111
    ds_read_b96 v[8:10], v6 offset:256
    s_cmp_ge_i32 s60, s63
    s_cbranch_scc1 L_gob0_recurren
    s_sub_u32 s28, s28, 1
    s_cmp_gt_i32 s28, 0
    s_cbranch_scc1 L_chkb0_recurren
L_gob0_recurren:
    s_add_u32 m0, s58, 0
    s_waitcnt vmcnt(31)
    buffer_load_dwordx4 v3, s[48:51], s56 offen offset:0 nt lds
    s_add_u32 m0, s58, 512
    s_waitcnt vmcnt(31)
    buffer_load_dwordx4 v3, s[48:51], s56 offen offset:512 nt lds
    s_add_u32 m0, s58, 1024
    s_waitcnt vmcnt(31)
    buffer_load_dwordx4 v3, s[48:51], s56 offen offset:1024 nt lds
    s_add_u32 m0, s58, 1536
    s_waitcnt vmcnt(31)
    v_mov_b32 v5, 1952
    ds_write_b32 v4, v5
    buffer_load_dwordx4 v3, s[48:51], s56 offen offset:1536 nt lds
    s_add_u32 m0, s58, 2048
    s_waitcnt vmcnt(31)
    buffer_load_dwordx4 v3, s[48:51], s56 offen offset:2048 nt lds
    s_add_u32 m0, s58, 2560
    s_waitcnt vmcnt(31)
    buffer_load_dwordx4 v3, s[48:51], s56 offen offset:2560 nt lds
    s_add_u32 m0, s58, 3072
    s_waitcnt vmcnt(31)
    buffer_load_dwordx4 v3, s[48:51], s56 offen offset:3072 nt lds
    s_add_u32 m0, s58, 3584
    s_waitcnt vmcnt(31)
    v_mov_b32 v5, 1956
    ds_write_b32 v4, v5
    buffer_load_dwordx4 v3, s[48:51], s56 offen offset:3584 nt lds
    s_add_u32 m0, s58, 8192
    s_waitcnt vmcnt(31)
    buffer_load_dwordx4 v3, s[48:51], s57 offen offset:0 nt lds
    s_add_u32 m0, s58, 8704
    s_waitcnt vmcnt(31)
    buffer_load_dwordx4 v3, s[48:51], s57 offen offset:512 nt lds
    s_add_u32 m0, s58, 9216
    s_waitcnt vmcnt(31)
    buffer_load_dwordx4 v3, s[48:51], s57 offen offset:1024 nt lds
    s_add_u32 m0, s58, 9728
    s_waitcnt vmcnt(31)
    v_mov_b32 v5, 1960
    ds_write_b32 v4, v5
    buffer_load_dwordx4 v3, s[48:51], s57 offen offset:1536 nt lds
    s_add_u32 m0, s58, 10240
    s_waitcnt vmcnt(31)
    buffer_load_dwordx4 v3, s[48:51], s57 offen offset:2048 nt lds
    s_add_u32 m0, s58, 10752
    s_waitcnt vmcnt(31)
    buffer_load_dwordx4 v3, s[48:51], s57 offen offset:2560 nt lds
    s_add_u32 m0, s58, 11264
    s_waitcnt vmcnt(31)
    buffer_load_dwordx4 v3, s[48:51], s57 offen offset:3072 nt lds
    s_add_u32 m0, s58, 11776
    s_waitcnt vmcnt(31)
    v_mov_b32 v5, 1964
    ds_write_b32 v4, v5
    buffer_load_dwordx4 v3, s[48:51], s57 offen offset:3584 nt lds
    s_add_u32 s59, s59, 1
    s_xor_b32 s56, s31, s59
    s_and_b32 s56, s56, 15
    s_lshl_b32 s56, s56, 14
    s_and_b32 s57, s59, 63
    s_lshl_b32 s57, s57, 18
    s_add_u32 s56, s56, s57
    s_add_u32 s57, s56, 4096
    s_and_b32 s58, s59, 7
    s_lshl_b32 s58, s58, 14
    s_sub_u32 s63, s59, 6
    s_ashr_i32 s63, s63, 1
L_chkb1_recurren:
    s_waitcnt lgkmcnt(0)
    v_readfirstlane_b32 s60, v8
    v_readfirstlane_b32 s61, v9
    v_readfirstlane_b32 s40, v10
    s_bitcmp1_b32 s59, 0
    s_cselect_b32 s60, s61, s60
    s_xor_b32 s40, s40, 0x1111
    ds_read_b96 v[8:10], v6 offset:256
    s_cmp_ge_i32 s60, s63
    s_cbranch_scc1 L_gob1_recurren
    s_sub_u32 s28, s28, 1
    s_cmp_gt_i32 s28, 0
    s_cbranch_scc1 L_chkb1_recurren
L_gob1_recurren:
    s_add_u32 m0, s58, 0
    s_waitcnt vmcnt(31)
    buffer_load_dwordx4 v3, s[48:51], s56 offen offset:0 nt lds
    s_add_u32 m0, s58, 512
    s_waitcnt vmcnt(31)
    buffer_load_dwordx4 v3, s[48:51], s56 offen offset:512 nt lds
    s_add_u32 m0, s58, 1024
    s_waitcnt vmcnt(31)
    buffer_load_dwordx4 v3, s[48:51], s56 offen offset:1024 nt lds
    s_add_u32 m0, s58, 1536
    s_waitcnt vmcnt(31)
    v_mov_b32 v5, 1968
    ds_write_b32 v4, v5
    buffer_load_dwordx4 v3, s[48:51], s56 offen offset:1536 nt lds
    s_add_u32 m0, s58, 2048
    s_waitcnt vmcnt(31)
    buffer_load_dwordx4 v3, s[48:51], s56 offen offset:2048 nt lds
    s_add_u32 m0, s58, 2560
    s_waitcnt vmcnt(31)
    buffer_load_dwordx4 v3, s[48:51], s56 offen offset:2560 nt lds
    s_add_u32 m0, s58, 3072
    s_waitcnt vmcnt(31)
    buffer_load_dwordx4 v3, s[48:51], s56 offen offset:3072 nt lds
    s_add_u32 m0, s58, 3584
    s_waitcnt vmcnt(31)
    v_mov_b32 v5, 1972
    ds_write_b32 v4, v5
    buffer_load_dwordx4 v3, s[48:51], s56 offen offset:3584 nt lds
    s_add_u32 m0, s58, 8192
    s_waitcnt vmcnt(31)
    buffer_load_dwordx4 v3, s[48:51], s57 offen offset:0 nt lds
    s_add_u32 m0, s58, 8704
    s_waitcnt vmcnt(31)
    buffer_load_dwordx4 v3, s[48:51], s57 offen offset:512 nt lds
    s_add_u32 m0, s58, 9216
    s_waitcnt vmcnt(31)
    buffer_load_dwordx4 v3, s[48:51], s57 offen offset:1024 nt lds
    s_add_u32 m0, s58, 9728
    s_waitcnt vmcnt(31)
    v_mov_b32 v5, 1976
    ds_write_b32 v4, v5
    buffer_load_dwordx4 v3, s[48:51], s57 offen offset:1536 nt lds
    s_add_u32 m0, s58, 10240
    s_waitcnt vmcnt(31)
    buffer_load_dwordx4 v3, s[48:51], s57 offen offset:2048 nt lds
    s_add_u32 m0, s58, 10752
    s_waitcnt vmcnt(31)
    buffer_load_dwordx4 v3, s[48:51], s57 offen offset:2560 nt lds
    s_add_u32 m0, s58, 11264
    s_waitcnt vmcnt(31)
    buffer_load_dwordx4 v3, s[48:51], s57 offen offset:3072 nt lds
    s_add_u32 m0, s58, 11776
    s_waitcnt vmcnt(31)
    v_mov_b32 v5, 1980
    ds_write_b32 v4, v5
    buffer_load_dwordx4 v3, s[48:51], s57 offen offset:3584 nt lds
    s_add_u32 s59, s59, 1
    s_xor_b32 s56, s31, s59
    s_and_b32 s56, s56, 15
    s_lshl_b32 s56, s56, 14
    s_and_b32 s57, s59, 63
    s_lshl_b32 s57, s57, 18
    s_add_u32 s56, s56, s57
    s_add_u32 s57, s56, 4096
    s_and_b32 s58, s59, 7
    s_lshl_b32 s58, s58, 14
    s_sub_u32 s63, s59, 6
    s_ashr_i32 s63, s63, 1
L_chkb2_recurren:
    s_waitcnt lgkmcnt(0)
    v_readfirstlane_b32 s60, v8
    v_readfirstlane_b32 s61, v9
    v_readfirstlane_b32 s40, v10
    s_bitcmp1_b32 s59, 0
    s_cselect_b32 s60, s61, s60
    s_xor_b32 s40, s40, 0x1111
    ds_read_b96 v[8:10], v6 offset:256
    s_cmp_ge_i32 s60, s63
    s_cbranch_scc1 L_gob2_recurren
    s_sub_u32 s28, s28, 1
    s_cmp_gt_i32 s28, 0
    s_cbranch_scc1 L_chkb2_recurren
L_gob2_recurren:
    s_add_u32 m0, s58, 0
    s_waitcnt vmcnt(31)
    buffer_load_dwordx4 v3, s[48:51], s56 offen offset:0 nt lds
    s_add_u32 m0, s58, 512
    s_waitcnt vmcnt(31)
    buffer_load_dwordx4 v3, s[48:51], s56 offen offset:512 nt lds
    s_add_u32 m0, s58, 1024
    s_waitcnt vmcnt(31)
    buffer_load_dwordx4 v3, s[48:51], s56 offen offset:1024 nt lds
    s_add_u32 m0, s58, 1536
    s_waitcnt vmcnt(31)
    v_mov_b32 v5, 1984
    ds_write_b32 v4, v5
    buffer_load_dwordx4 v3, s[48:51], s56 offen offset:1536 nt lds
    s_add_u32 m0, s58, 2048
    s_waitcnt vmcnt(31)
    buffer_load_dwordx4 v3, s[48:51], s56 offen offset:2048 nt lds
    s_add_u32 m0, s58, 2560
    s_waitcnt vmcnt(31)
    buffer_load_dwordx4 v3, s[48:51], s56 offen offset:2560 nt lds
    s_add_u32 m0, s58, 3072
    s_waitcnt vmcnt(31)
    buffer_load_dwordx4 v3, s[48:51], s56 offen offset:3072 nt lds
    s_add_u32 m0, s58, 3584
    s_waitcnt vmcnt(31)
    v_mov_b32 v5, 1988
    ds_write_b32 v4, v5
    buffer_load_dwordx4 v3, s[48:51], s56 offen offset:3584 nt lds
    s_add_u32 m0, s58, 8192
    s_waitcnt vmcnt(31)
    buffer_load_dwordx4 v3, s[48:51], s57 offen offset:0 nt lds
    s_add_u32 m0, s58, 8704
    s_waitcnt vmcnt(31)
    buffer_load_dwordx4 v3, s[48:51], s57 offen offset:512 nt lds
    s_add_u32 m0, s58, 9216
    s_waitcnt vmcnt(31)
    buffer_load_dwordx4 v3, s[48:51], s57 offen offset:1024 nt lds
    s_add_u32 m0, s58, 9728
    s_waitcnt vmcnt(31)
    v_mov_b32 v5, 1992
    ds_write_b32 v4, v5
    buffer_load_dwordx4 v3, s[48:51], s57 offen offset:1536 nt lds
    s_add_u32 m0, s58, 10240
    s_waitcnt vmcnt(31)
    buffer_load_dwordx4 v3, s[48:51], s57 offen offset:2048 nt lds
    s_add_u32 m0, s58, 10752
    s_waitcnt vmcnt(31)
    buffer_load_dwordx4 v3, s[48:51], s57 offen offset:2560 nt lds
    s_add_u32 m0, s58, 11264
    s_waitcnt vmcnt(31)
    buffer_load_dwordx4 v3, s[48:51], s57 offen offset:3072 nt lds
    s_add_u32 m0, s58, 11776
    s_waitcnt vmcnt(31)
    v_mov_b32 v5, 1996
    ds_write_b32 v4, v5
    buffer_load_dwordx4 v3, s[48:51], s57 offen offset:3584 nt lds
    s_add_u32 s59, s59, 1
    s_xor_b32 s56, s31, s59
    s_and_b32 s56, s56, 15
    s_lshl_b32 s56, s56, 14
    s_and_b32 s57, s59, 63
    s_lshl_b32 s57, s57, 18
    s_add_u32 s56, s56, s57
    s_add_u32 s57, s56, 4096
    s_and_b32 s58, s59, 7
    s_lshl_b32 s58, s58, 14
    s_sub_u32 s63, s59, 6
    s_ashr_i32 s63, s63, 1
L_chkb3_recurren:
    s_waitcnt lgkmcnt(0)
    v_readfirstlane_b32 s60, v8
    v_readfirstlane_b32 s61, v9
    v_readfirstlane_b32 s40, v10
    s_bitcmp1_b32 s59, 0
    s_cselect_b32 s60, s61, s60
    s_xor_b32 s40, s40, 0x1111
    ds_read_b96 v[8:10], v6 offset:256
    s_cmp_ge_i32 s60, s63
    s_cbranch_scc1 L_gob3_recurren
    s_sub_u32 s28, s28, 1
    s_cmp_gt_i32 s28, 0
    s_cbranch_scc1 L_chkb3_recurren
L_gob3_recurren:
    s_add_u32 m0, s58, 0
    s_waitcnt vmcnt(31)
    buffer_load_dwordx4 v3, s[48:51], s56 offen offset:0 nt lds
    s_add_u32 m0, s58, 512
    s_waitcnt vmcnt(31)
    buffer_load_dwordx4 v3, s[48:51], s56 offen offset:512 nt lds
    s_add_u32 m0, s58, 1024
    s_waitcnt vmcnt(31)
    buffer_load_dwordx4 v3, s[48:51], s56 offen offset:1024 nt lds
    s_add_u32 m0, s58, 1536
    s_waitcnt vmcnt(31)
    v_mov_b32 v5, 2000
    ds_write_b32 v4, v5
    buffer_load_dwordx4 v3, s[48:51], s56 offen offset:1536 nt lds
    s_add_u32 m0, s58, 2048
    s_waitcnt vmcnt(31)
    buffer_load_dwordx4 v3, s[48:51], s56 offen offset:2048 nt lds
    s_add_u32 m0, s58, 2560
    s_waitcnt vmcnt(31)
    buffer_load_dwordx4 v3, s[48:51], s56 offen offset:2560 nt lds
    s_add_u32 m0, s58, 3072
    s_waitcnt vmcnt(31)
    buffer_load_dwordx4 v3, s[48:51], s56 offen offset:3072 nt lds
    s_add_u32 m0, s58, 3584
    s_waitcnt vmcnt(31)
    v_mov_b32 v5, 2004
    ds_write_b32 v4, v5
    buffer_load_dwordx4 v3, s[48:51], s56 offen offset:3584 nt lds
    s_add_u32 m0, s58, 8192
    s_waitcnt vmcnt(31)
    buffer_load_dwordx4 v3, s[48:51], s57 offen offset:0 nt lds
    s_add_u32 m0, s58, 8704
    s_waitcnt vmcnt(31)
    buffer_load_dwordx4 v3, s[48:51], s57 offen offset:512 nt lds
    s_add_u32 m0, s58, 9216
    s_waitcnt vmcnt(31)
    buffer_load_dwordx4 v3, s[48:51], s57 offen offset:1024 nt lds
    s_add_u32 m0, s58, 9728
    s_waitcnt vmcnt(31)
    v_mov_b32 v5, 2008
    ds_write_b32 v4, v5
    buffer_load_dwordx4 v3, s[48:51], s57 offen offset:1536 nt lds
    s_add_u32 m0, s58, 10240
    s_waitcnt vmcnt(31)
    buffer_load_dwordx4 v3, s[48:51], s57 offen offset:2048 nt lds
    s_add_u32 m0, s58, 10752
    s_waitcnt vmcnt(31)
    buffer_load_dwordx4 v3, s[48:51], s57 offen offset:2560 nt lds
    s_add_u32 m0, s58, 11264
    s_waitcnt vmcnt(31)
    buffer_load_dwordx4 v3, s[48:51], s57 offen offset:3072 nt lds
    s_add_u32 m0, s58, 11776
    s_waitcnt vmcnt(31)
    v_mov_b32 v5, 2012
    ds_write_b32 v4, v5
    buffer_load_dwordx4 v3, s[48:51], s57 offen offset:3584 nt lds
    s_add_u32 s59, s59, 1
    s_xor_b32 s56, s31, s59
    s_and_b32 s56, s56, 15
    s_lshl_b32 s56, s56, 14
    s_and_b32 s57, s59, 63
    s_lshl_b32 s57, s57, 18
    s_add_u32 s56, s56, s57
    s_add_u32 s57, s56, 4096
    s_and_b32 s58, s59, 7
    s_lshl_b32 s58, s58, 14
    s_sub_u32 s63, s59, 6
    s_ashr_i32 s63, s63, 1
L_chkb4_recurren:
    s_waitcnt lgkmcnt(0)
    v_readfirstlane_b32 s60, v8
    v_readfirstlane_b32 s61, v9
    v_readfirstlane_b32 s40, v10
    s_bitcmp1_b32 s59, 0
    s_cselect_b32 s60, s61, s60
    s_xor_b32 s40, s40, 0x1111
    ds_read_b96 v[8:10], v6 offset:256
    s_cmp_ge_i32 s60, s63
    s_cbranch_scc1 L_gob4_recurren
    s_sub_u32 s28, s28, 1
    s_cmp_gt_i32 s28, 0
    s_cbranch_scc1 L_chkb4_recurren
L_gob4_recurren:
    s_add_u32 m0, s58, 0
    s_waitcnt vmcnt(31)
    buffer_load_dwordx4 v3, s[48:51], s56 offen offset:0 nt lds
    s_add_u32 m0, s58, 512
    s_waitcnt vmcnt(31)
    buffer_load_dwordx4 v3, s[48:51], s56 offen offset:512 nt lds
    s_add_u32 m0, s58, 1024
    s_waitcnt vmcnt(31)
    buffer_load_dwordx4 v3, s[48:51], s56 offen offset:1024 nt lds
    s_add_u32 m0, s58, 1536
    s_waitcnt vmcnt(31)
    v_mov_b32 v5, 2016
    ds_write_b32 v4, v5
    buffer_load_dwordx4 v3, s[48:51], s56 offen offset:1536 nt lds
    s_add_u32 m0, s58, 2048
    s_waitcnt vmcnt(31)
    buffer_load_dwordx4 v3, s[48:51], s56 offen offset:2048 nt lds
    s_add_u32 m0, s58, 2560
    s_waitcnt vmcnt(31)
    buffer_load_dwordx4 v3, s[48:51], s56 offen offset:2560 nt lds
    s_add_u32 m0, s58, 3072
    s_waitcnt vmcnt(31)
    buffer_load_dwordx4 v3, s[48:51], s56 offen offset:3072 nt lds
    s_add_u32 m0, s58, 3584
    s_waitcnt vmcnt(31)
    v_mov_b32 v5, 2020
    ds_write_b32 v4, v5
    buffer_load_dwordx4 v3, s[48:51], s56 offen offset:3584 nt lds
    s_add_u32 m0, s58, 8192
    s_waitcnt vmcnt(31)
    buffer_load_dwordx4 v3, s[48:51], s57 offen offset:0 nt lds
    s_add_u32 m0, s58, 8704
    s_waitcnt vmcnt(31)
    buffer_load_dwordx4 v3, s[48:51], s57 offen offset:512 nt lds
    s_add_u32 m0, s58, 9216
    s_waitcnt vmcnt(31)
    buffer_load_dwordx4 v3, s[48:51], s57 offen offset:1024 nt lds
    s_add_u32 m0, s58, 9728
    s_waitcnt vmcnt(31)
    v_mov_b32 v5, 2024
    ds_write_b32 v4, v5
    buffer_load_dwordx4 v3, s[48:51], s57 offen offset:1536 nt lds
    s_add_u32 m0, s58, 10240
    s_waitcnt vmcnt(31)
    buffer_load_dwordx4 v3, s[48:51], s57 offen offset:2048 nt lds
    s_add_u32 m0, s58, 10752
    s_waitcnt vmcnt(31)
    buffer_load_dwordx4 v3, s[48:51], s57 offen offset:2560 nt lds
    s_add_u32 m0, s58, 11264
    s_waitcnt vmcnt(31)
    buffer_load_dwordx4 v3, s[48:51], s57 offen offset:3072 nt lds
    s_add_u32 m0, s58, 11776
    s_waitcnt vmcnt(31)
    v_mov_b32 v5, 2028
    ds_write_b32 v4, v5
    buffer_load_dwordx4 v3, s[48:51], s57 offen offset:3584 nt lds
    s_add_u32 s59, s59, 1
    s_xor_b32 s56, s31, s59
    s_and_b32 s56, s56, 15
    s_lshl_b32 s56, s56, 14
    s_and_b32 s57, s59, 63
    s_lshl_b32 s57, s57, 18
    s_add_u32 s56, s56, s57
    s_add_u32 s57, s56, 4096
    s_and_b32 s58, s59, 7
    s_lshl_b32 s58, s58, 14
    s_sub_u32 s63, s59, 6
    s_ashr_i32 s63, s63, 1
L_chkb5_recurren:
    s_waitcnt lgkmcnt(0)
    v_readfirstlane_b32 s60, v8
    v_readfirstlane_b32 s61, v9
    v_readfirstlane_b32 s40, v10
    s_bitcmp1_b32 s59, 0
    s_cselect_b32 s60, s61, s60
    s_xor_b32 s40, s40, 0x1111
    ds_read_b96 v[8:10], v6 offset:256
    s_cmp_ge_i32 s60, s63
    s_cbranch_scc1 L_gob5_recurren
    s_sub_u32 s28, s28, 1
    s_cmp_gt_i32 s28, 0
    s_cbranch_scc1 L_chkb5_recurren
L_gob5_recurren:
    s_add_u32 m0, s58, 0
    s_waitcnt vmcnt(31)
    buffer_load_dwordx4 v3, s[48:51], s56 offen offset:0 nt lds
    s_add_u32 m0, s58, 512
    s_waitcnt vmcnt(31)
    buffer_load_dwordx4 v3, s[48:51], s56 offen offset:512 nt lds
    s_add_u32 m0, s58, 1024
    s_waitcnt vmcnt(31)
    buffer_load_dwordx4 v3, s[48:51], s56 offen offset:1024 nt lds
    s_add_u32 m0, s58, 1536
    s_waitcnt vmcnt(31)
    v_mov_b32 v5, 2032
    ds_write_b32 v4, v5
    buffer_load_dwordx4 v3, s[48:51], s56 offen offset:1536 nt lds
    s_add_u32 m0, s58, 2048
    s_waitcnt vmcnt(31)
    buffer_load_dwordx4 v3, s[48:51], s56 offen offset:2048 nt lds
    s_add_u32 m0, s58, 2560
    s_waitcnt vmcnt(31)
    buffer_load_dwordx4 v3, s[48:51], s56 offen offset:2560 nt lds
    s_add_u32 m0, s58, 3072
    s_waitcnt vmcnt(31)
    buffer_load_dwordx4 v3, s[48:51], s56 offen offset:3072 nt lds
    s_add_u32 m0, s58, 3584
    s_waitcnt vmcnt(31)
    v_mov_b32 v5, 2036
    ds_write_b32 v4, v5
    buffer_load_dwordx4 v3, s[48:51], s56 offen offset:3584 nt lds
    s_add_u32 m0, s58, 8192
    s_waitcnt vmcnt(31)
    buffer_load_dwordx4 v3, s[48:51], s57 offen offset:0 nt lds
    s_add_u32 m0, s58, 8704
    s_waitcnt vmcnt(31)
    buffer_load_dwordx4 v3, s[48:51], s57 offen offset:512 nt lds
    s_add_u32 m0, s58, 9216
    s_waitcnt vmcnt(31)
    buffer_load_dwordx4 v3, s[48:51], s57 offen offset:1024 nt lds
    s_add_u32 m0, s58, 9728
    s_waitcnt vmcnt(31)
    v_mov_b32 v5, 2040
    ds_write_b32 v4, v5
    buffer_load_dwordx4 v3, s[48:51], s57 offen offset:1536 nt lds
    s_add_u32 m0, s58, 10240
    s_waitcnt vmcnt(31)
    buffer_load_dwordx4 v3, s[48:51], s57 offen offset:2048 nt lds
    s_add_u32 m0, s58, 10752
    s_waitcnt vmcnt(31)
    buffer_load_dwordx4 v3, s[48:51], s57 offen offset:2560 nt lds
    s_add_u32 m0, s58, 11264
    s_waitcnt vmcnt(31)
    buffer_load_dwordx4 v3, s[48:51], s57 offen offset:3072 nt lds
    s_add_u32 m0, s58, 11776
    s_waitcnt vmcnt(31)
    v_mov_b32 v5, 2044
    ds_write_b32 v4, v5
    buffer_load_dwordx4 v3, s[48:51], s57 offen offset:3584 nt lds
    s_add_u32 s59, s59, 1
    s_waitcnt vmcnt(28)
    v_mov_b32 v5, 2048
    ds_write_b32 v4, v5
    s_waitcnt vmcnt(24)
    v_mov_b32 v5, 2052
    ds_write_b32 v4, v5
    s_waitcnt vmcnt(20)
    v_mov_b32 v5, 2056
    ds_write_b32 v4, v5
    s_waitcnt vmcnt(16)
    v_mov_b32 v5, 2060
    ds_write_b32 v4, v5
    s_waitcnt vmcnt(12)
    v_mov_b32 v5, 2064
    ds_write_b32 v4, v5
    s_waitcnt vmcnt(8)
    v_mov_b32 v5, 2068
    ds_write_b32 v4, v5
    s_waitcnt vmcnt(4)
    v_mov_b32 v5, 2072
    ds_write_b32 v4, v5
    s_waitcnt vmcnt(0)
    v_mov_b32 v5, 2076
    ds_write_b32 v4, v5
    s_endpgm
L_w1_recurren:
    v_lshrrev_b32 v2, 5, v0
    v_mul_u32_u24 v4, 896, v2
    v_and_b32 v2, 31, v0
    v_mad_u32_u24 v4, v2, 28, v4
    v_mov_b32 v3, 0
    v_mov_b32 v1, 0x27700
    s_barrier
    s_waitcnt lgkmcnt(0)
    s_mov_b32 s32, s4
    s_mov_b32 s33, s5
    s_mov_b32 s34, 0x700
    s_mov_b32 s35, 0x20000
    buffer_load_dwordx4 v[112:115], v4, s[32:35], 0 offen
    buffer_load_dwordx3 v[116:118], v4, s[32:35], 0 offen offset:16
    s_mov_b32 s36, s26
    s_mov_b32 s37, s27
    s_mov_b32 s38, 0x1000000
    s_mov_b32 s39, 0x20000
    buffer_load_dword v18, v3, s[36:39], 0 offen offset:0 sc1
    v_add_u32 v4, 0x27000, v4
    s_and_b32 s46, s2, 3
    s_mul_i32 s46, s46, 224
    s_add_u32 s46, s46, 0x27000
    v_and_b32 v2, 1, v0
    v_mul_u32_u24 v5, 896, v2
    v_add_u32 v5, s46, v5
    v_bfe_u32 v2, v0, 2, 2
    v_lshlrev_b32 v7, 7, v2
    v_and_b32 v2, 3, v0
    v_lshl_add_u32 v7, v2, 3, v7
    v_add_u32 v7, 0x20000, v7
    v_lshrrev_b32 v2, 4, v0
    v_lshl_add_u32 v6, v2, 3, v5
    v_lshl_add_u32 v5, v2, 4, v5
    v_lshl_add_u32 v8, v2, 9, v7
    v_lshl_add_u32 v7, v2, 10, v7
    s_mov_b32 s53, 0x3ff
    s_and_b32 s46, s2, 3
    s_lshl_b32 s46, s46, 14
    s_lshr_b32 s47, s2, 2
    s_lshl_b32 s47, s47, 8
    s_add_u32 s48, s46, s47
    s_add_u32 s48, s48, 0x20000
    s_waitcnt vmcnt(1)
    v_lshlrev_b32 v96, 16, v112
    v_and_b32 v97, 0xffff0000, v112
    v_lshlrev_b32 v98, 16, v113
    v_and_b32 v99, 0xffff0000, v113
    v_lshlrev_b32 v100, 16, v114
    v_and_b32 v101, 0xffff0000, v114
    v_lshlrev_b32 v102, 16, v115
    v_and_b32 v103, 0xffff0000, v115
    v_lshlrev_b32 v104, 16, v116
    v_and_b32 v105, 0xffff0000, v116
    v_lshlrev_b32 v106, 16, v117
    v_and_b32 v107, 0xffff0000, v117
    v_lshlrev_b32 v108, 16, v118
    v_and_b32 v109, 0xffff0000, v118
    v_add_f32 v112, v96, v97
    v_add_f32 v113, v98, v99
    v_add_f32 v114, v100, v101
    v_add_f32 v115, v102, v103
    v_add_f32 v116, v104, v105
    v_add_f32 v117, v106, v107
    v_add_f32 v118, v108, v109
    v_add_f32 v112, v112, v113
    v_add_f32 v114, v114, v115
    v_add_f32 v116, v116, v117
    v_add_f32 v112, v112, v114
    v_add_f32 v116, v116, v118
    v_add_f32 v112, v112, v116
    s_nop 1
    v_add_f32_dpp v112, v112, v112 row_ror:8 row_mask:0xf bank_mask:0xf
    s_nop 1
    v_add_f32_dpp v112, v112, v112 row_ror:4 row_mask:0xf bank_mask:0xf
    s_nop 1
    v_add_f32_dpp v112, v112, v112 row_ror:2 row_mask:0xf bank_mask:0xf
    s_nop 1
    v_add_f32_dpp v112, v112, v112 row_ror:1 row_mask:0xf bank_mask:0xf
    s_nop 1
    v_mov_b32 v113, v112
    s_nop 1
    v_permlane16_swap_b32 v112, v113
    v_add_f32 v112, v112, v113
    v_mul_f32 v112, 0x3b124925, v112
    v_sub_f32 v128, v96, v112
    v_sub_f32 v129, v97, v112
    v_sub_f32 v130, v98, v112
    v_sub_f32 v131, v99, v112
    v_sub_f32 v132, v100, v112
    v_sub_f32 v133, v101, v112
    v_sub_f32 v134, v102, v112
    v_sub_f32 v135, v103, v112
    v_sub_f32 v136, v104, v112
    v_sub_f32 v137, v105, v112
    v_sub_f32 v138, v106, v112
    v_sub_f32 v139, v107, v112
    v_sub_f32 v140, v108, v112
    v_sub_f32 v141, v109, v112
    v_cvt_pk_bf16_f32 v114, v112, v112
    v_and_b32 v114, 0xffff0000, v114
    v_mul_f32 v112, v128, v128
    v_mul_f32 v113, v129, v129
    v_fmac_f32 v112, v130, v130
    v_fmac_f32 v113, v131, v131
    v_fmac_f32 v112, v132, v132
    v_fmac_f32 v113, v133, v133
    v_fmac_f32 v112, v134, v134
    v_fmac_f32 v113, v135, v135
    v_fmac_f32 v112, v136, v136
    v_fmac_f32 v113, v137, v137
    v_fmac_f32 v112, v138, v138
    v_fmac_f32 v113, v139, v139
    v_fmac_f32 v112, v140, v140
    v_fmac_f32 v113, v141, v141
    v_add_f32 v112, v112, v113
    v_sub_f32 v96, v96, v114
    v_sub_f32 v97, v97, v114
    v_sub_f32 v98, v98, v114
    v_sub_f32 v99, v99, v114
    v_sub_f32 v100, v100, v114
    v_sub_f32 v101, v101, v114
    v_sub_f32 v102, v102, v114
    v_sub_f32 v103, v103, v114
    v_sub_f32 v104, v104, v114
    v_sub_f32 v105, v105, v114
    v_sub_f32 v106, v106, v114
    v_sub_f32 v107, v107, v114
    v_sub_f32 v108, v108, v114
    v_sub_f32 v109, v109, v114
    v_add_f32_dpp v112, v112, v112 row_ror:8 row_mask:0xf bank_mask:0xf
    s_nop 1
    v_add_f32_dpp v112, v112, v112 row_ror:4 row_mask:0xf bank_mask:0xf
    s_nop 1
    v_add_f32_dpp v112, v112, v112 row_ror:2 row_mask:0xf bank_mask:0xf
    s_nop 1
    v_add_f32_dpp v112, v112, v112 row_ror:1 row_mask:0xf bank_mask:0xf
    s_nop 1
    v_mov_b32 v113, v112
    s_nop 1
    v_permlane16_swap_b32 v112, v113
    v_add_f32 v112, v112, v113
    v_mul_f32 v112, 0x3b124925, v112
    v_cvt_pk_bf16_f32 v112, v112, v112
    v_and_b32 v112, 0xffff0000, v112
    v_add_f32 v112, 0x3727c5ac, v112
    v_cvt_pk_bf16_f32 v112, v112, v112
    v_and_b32 v112, 0xffff0000, v112
    v_sqrt_f32 v112, v112
    v_cvt_pk_bf16_f32 v128, v96, v97
    v_cvt_pk_bf16_f32 v129, v98, v99
    v_cvt_pk_bf16_f32 v130, v100, v101
    v_cvt_pk_bf16_f32 v131, v102, v103
    v_cvt_pk_bf16_f32 v132, v104, v105
    v_cvt_pk_bf16_f32 v133, v106, v107
    v_cvt_pk_bf16_f32 v134, v108, v109
    v_cvt_pk_bf16_f32 v112, v112, v112
    v_and_b32 v112, 0xffff0000, v112
    v_rcp_f32 v112, v112
    v_lshlrev_b32 v96, 16, v128
    v_and_b32 v97, 0xffff0000, v128
    v_lshlrev_b32 v98, 16, v129
    v_and_b32 v99, 0xffff0000, v129
    v_lshlrev_b32 v100, 16, v130
    v_and_b32 v101, 0xffff0000, v130
    v_lshlrev_b32 v102, 16, v131
    v_and_b32 v103, 0xffff0000, v131
    v_lshlrev_b32 v104, 16, v132
    v_and_b32 v105, 0xffff0000, v132
    v_lshlrev_b32 v106, 16, v133
    v_and_b32 v107, 0xffff0000, v133
    v_lshlrev_b32 v108, 16, v134
    v_and_b32 v109, 0xffff0000, v134
    v_mul_f32 v96, v96, v112
    v_mul_f32 v97, v97, v112
    v_mul_f32 v98, v98, v112
    v_mul_f32 v99, v99, v112
    v_mul_f32 v100, v100, v112
    v_mul_f32 v101, v101, v112
    v_mul_f32 v102, v102, v112
    v_mul_f32 v103, v103, v112
    v_mul_f32 v104, v104, v112
    v_mul_f32 v105, v105, v112
    v_mul_f32 v106, v106, v112
    v_mul_f32 v107, v107, v112
    v_mul_f32 v108, v108, v112
    v_mul_f32 v109, v109, v112
    v_cvt_pk_bf16_f32 v128, v96, v97
    ds_write_b32 v4, v128 offset:0
    v_cvt_pk_bf16_f32 v129, v98, v99
    ds_write_b32 v4, v129 offset:4
    v_cvt_pk_bf16_f32 v130, v100, v101
    ds_write_b32 v4, v130 offset:8
    v_cvt_pk_bf16_f32 v131, v102, v103
    ds_write_b32 v4, v131 offset:12
    v_cvt_pk_bf16_f32 v132, v104, v105
    ds_write_b32 v4, v132 offset:16
    v_cvt_pk_bf16_f32 v133, v106, v107
    ds_write_b32 v4, v133 offset:20
    v_cvt_pk_bf16_f32 v134, v108, v109
    ds_write_b32 v4, v134 offset:24
    v_mov_b32 v23, 1
    s_waitcnt vmcnt(0)
    s_mov_b32 s46, 0x9e3779b1
    v_mul_lo_u32 v18, s46, v18
    v_add_u32 v18, 0x7f4a7c15, v18
    ds_write_b32 v1, v18 offset:280
    v_bfe_u32 v14, v18, 0, 10
    v_bfe_u32 v15, v18, 8, 10
    v_bfe_u32 v16, v18, 16, 10
    v_bfe_u32 v17, v18, 24, 10
    s_waitcnt lgkmcnt(0)
L_p1_recurren:
    ds_read_b32 v2, v1 offset:0
    s_waitcnt lgkmcnt(0)
    v_readfirstlane_b32 s41, v2
    s_cmp_ge_i32 s41, 14
    s_cbranch_scc1 L_q1_recurren
    s_sleep 1
    s_sub_u32 s28, s28, 1
    s_cmp_gt_i32 s28, 0
    s_cbranch_scc1 L_p1_recurren
L_q1_recurren:
    ds_read_b64 v[164:165], v6 offset:192
    ds_read_b64_tr_b16 v[144:145], v8 offset:12288
    ds_read_b64_tr_b16 v[146:147], v8 offset:12320
    ds_read_b64_tr_b16 v[148:149], v8 offset:12352
    ds_read_b64_tr_b16 v[150:151], v8 offset:12384
    ds_read_b128 v[152:155], v5 offset:0
    ds_read_b64_tr_b16 v[96:97], v7 offset:0
    ds_read_b64_tr_b16 v[98:99], v7 offset:512
    ds_read_b64_tr_b16 v[100:101], v7 offset:32
    ds_read_b64_tr_b16 v[102:103], v7 offset:544
    s_waitcnt lgkmcnt(11)
    ds_read_b64_tr_b16 v[104:105], v7 offset:64
    ds_read_b64_tr_b16 v[106:107], v7 offset:576
    ds_read_b64_tr_b16 v[108:109], v7 offset:96
    ds_read_b64_tr_b16 v[110:111], v7 offset:608
    s_waitcnt lgkmcnt(9)
    v_mfma_f32_16x16x16_bf16 v[64:67], v[164:165], v[144:145], 0
    v_mfma_f32_16x16x16_bf16 v[68:71], v[164:165], v[146:147], 0
    v_mfma_f32_16x16x16_bf16 v[72:75], v[164:165], v[148:149], 0
    v_mfma_f32_16x16x16_bf16 v[76:79], v[164:165], v[150:151], 0
    ds_read_b128 v[156:159], v5 offset:64
    ds_read_b64_tr_b16 v[112:113], v7 offset:4096
    ds_read_b64_tr_b16 v[114:115], v7 offset:4608
    ds_read_b64_tr_b16 v[116:117], v7 offset:4128
    ds_read_b64_tr_b16 v[118:119], v7 offset:4640
    s_waitcnt lgkmcnt(11)
    ds_read_b64_tr_b16 v[120:121], v7 offset:4160
    ds_read_b64_tr_b16 v[122:123], v7 offset:4672
    ds_read_b64_tr_b16 v[124:125], v7 offset:4192
    ds_read_b64_tr_b16 v[126:127], v7 offset:4704
    s_waitcnt lgkmcnt(9)
    v_mfma_f32_16x16x32_bf16 v[64:67], v[152:155], v[96:99], v[64:67]
    v_mfma_f32_16x16x32_bf16 v[68:71], v[152:155], v[100:103], v[68:71]
    v_mfma_f32_16x16x32_bf16 v[72:75], v[152:155], v[104:107], v[72:75]
    v_mfma_f32_16x16x32_bf16 v[76:79], v[152:155], v[108:111], v[76:79]
    ds_read_b128 v[160:163], v5 offset:128
    ds_read_b64_tr_b16 v[128:129], v7 offset:8192
    ds_read_b64_tr_b16 v[130:131], v7 offset:8704
    ds_read_b64_tr_b16 v[132:133], v7 offset:8224
    ds_read_b64_tr_b16 v[134:135], v7 offset:8736
    s_waitcnt lgkmcnt(11)
    ds_read_b64_tr_b16 v[136:137], v7 offset:8256
    ds_read_b64_tr_b16 v[138:139], v7 offset:8768
    ds_read_b64_tr_b16 v[140:141], v7 offset:8288
    ds_read_b64_tr_b16 v[142:143], v7 offset:8800
    s_waitcnt lgkmcnt(9)
    v_mfma_f32_16x16x32_bf16 v[64:67], v[156:159], v[112:115], v[64:67]
    v_mfma_f32_16x16x32_bf16 v[68:71], v[156:159], v[116:119], v[68:71]
    v_mfma_f32_16x16x32_bf16 v[72:75], v[156:159], v[120:123], v[72:75]
    v_mfma_f32_16x16x32_bf16 v[76:79], v[156:159], v[124:127], v[76:79]
    s_waitcnt lgkmcnt(0)
    v_mfma_f32_16x16x32_bf16 v[64:67], v[160:163], v[128:131], v[64:67]
    v_mfma_f32_16x16x32_bf16 v[68:71], v[160:163], v[132:135], v[68:71]
    v_mfma_f32_16x16x32_bf16 v[72:75], v[160:163], v[136:139], v[72:75]
    v_mfma_f32_16x16x32_bf16 v[76:79], v[160:163], v[140:143], v[76:79]
    s_lshr_b32 s46, s98, 7
    s_lshl_b32 s46, s46, 16
    s_bfe_u32 s47, s98, 0x30004
    s_lshl_b32 s47, s47, 11
    v_cmp_gt_u32 vcc, 16, v0
    v_lshrrev_b32 v28, 4, v0
    v_mul_u32_u24 v2, 0x10000, v28
    v_and_b32 v28, 15, v0
    v_lshl_add_u32 v2, v28, 4, v2
    v_cndmask_b32 v28, v65, v64, vcc
    v_cndmask_b32 v29, v69, v68, vcc
    v_cndmask_b32 v30, v73, v72, vcc
    v_cndmask_b32 v31, v77, v76, vcc
    v_add_u32 v28, 0x200, v28
    v_add_u32 v29, 0x200, v29
    v_add_u32 v30, 0x200, v30
    v_add_u32 v31, 0x200, v31
    v_bfi_b32 v28, s53, v14, v28
    v_bfi_b32 v29, s53, v15, v29
    v_bfi_b32 v30, s53, v16, v30
    v_bfi_b32 v31, s53, v17, v31
    s_mov_b32 exec_lo, 0xffffffff
    s_mov_b32 exec_hi, 0x0
    buffer_store_dwordx4 v[28:31], v2, s[36:39], s48 offen sc1
    s_mov_b64 exec, -1
    s_add_u32 s54, s46, s47
    s_add_u32 s54, s54, 0x20000
    s_add_u32 s55, s54, 0x4000
    s_add_u32 s56, s54, 0x8000
    s_add_u32 s57, s54, 0xc000
    v_lshlrev_b32 v7, 4, v0
    v_lshrrev_b32 v2, 4, v0
    v_lshlrev_b32 v8, 7, v2
    v_and_b32 v2, 15, v0
    v_lshl_add_u32 v8, v2, 1, v8
    v_add_u32 v8, 0x20000, v8
L_p2_recurren:
    ds_read_b32 v2, v1 offset:0
    s_waitcnt lgkmcnt(0)
    v_readfirstlane_b32 s41, v2
    s_cmp_ge_i32 s41, 60
    s_cbranch_scc1 L_q2_recurren
    s_sleep 1
    s_sub_u32 s28, s28, 1
    s_cmp_gt_i32 s28, 0
    s_cbranch_scc1 L_p2_recurren
L_q2_recurren:
    s_mov_b64 s[4:5], -1
    s_mov_b64 s[6:7], -1
    s_mov_b64 s[8:9], -1
    s_mov_b64 s[10:11], -1
    s_mov_b64 s[12:13], -1
    s_mov_b64 s[14:15], -1
    s_mov_b64 s[16:17], -1
    s_mov_b64 s[18:19], -1
L_gq_recurren:
    s_mov_b64 exec, s[4:5]
    buffer_load_dwordx4 v[96:99], v7, s[36:39], s54 offen offset:0 sc1
    s_mov_b64 exec, s[6:7]
    buffer_load_dwordx4 v[100:103], v7, s[36:39], s54 offen offset:1024 sc1
    s_mov_b64 exec, s[8:9]
    buffer_load_dwordx4 v[104:107], v7, s[36:39], s55 offen offset:0 sc1
    s_mov_b64 exec, s[10:11]
    buffer_load_dwordx4 v[108:111], v7, s[36:39], s55 offen offset:1024 sc1
    s_mov_b64 exec, s[12:13]
    buffer_load_dwordx4 v[112:115], v7, s[36:39], s56 offen offset:0 sc1
    s_mov_b64 exec, s[14:15]
    buffer_load_dwordx4 v[116:119], v7, s[36:39], s56 offen offset:1024 sc1
    s_mov_b64 exec, s[16:17]
    buffer_load_dwordx4 v[120:123], v7, s[36:39], s57 offen offset:0 sc1
    s_mov_b64 exec, s[18:19]
    buffer_load_dwordx4 v[124:127], v7, s[36:39], s57 offen offset:1024 sc1
    s_waitcnt vmcnt(0)
L_cq_recurren:
    s_mov_b64 exec, s[4:5]
    v_xor_b32 v96, v96, v14
    v_xor_b32 v97, v97, v15
    v_xor_b32 v98, v98, v16
    v_xor_b32 v99, v99, v17
    v_or3_b32 v2, v96, v97, v98
    v_bitop3_b32 v2, v2, v99, s53 bitop3:0xa8
    v_cmp_ne_u32 s[4:5], 0, v2
    s_mov_b64 exec, s[6:7]
    v_xor_b32 v100, v100, v14
    v_xor_b32 v101, v101, v15
    v_xor_b32 v102, v102, v16
    v_xor_b32 v103, v103, v17
    v_or3_b32 v2, v100, v101, v102
    v_bitop3_b32 v2, v2, v103, s53 bitop3:0xa8
    v_cmp_ne_u32 s[6:7], 0, v2
    s_mov_b64 exec, s[8:9]
    v_xor_b32 v104, v104, v14
    v_xor_b32 v105, v105, v15
    v_xor_b32 v106, v106, v16
    v_xor_b32 v107, v107, v17
    v_or3_b32 v2, v104, v105, v106
    v_bitop3_b32 v2, v2, v107, s53 bitop3:0xa8
    v_cmp_ne_u32 s[8:9], 0, v2
    s_mov_b64 exec, s[10:11]
    v_xor_b32 v108, v108, v14
    v_xor_b32 v109, v109, v15
    v_xor_b32 v110, v110, v16
    v_xor_b32 v111, v111, v17
    v_or3_b32 v2, v108, v109, v110
    v_bitop3_b32 v2, v2, v111, s53 bitop3:0xa8
    v_cmp_ne_u32 s[10:11], 0, v2
    s_mov_b64 exec, s[12:13]
    v_xor_b32 v112, v112, v14
    v_xor_b32 v113, v113, v15
    v_xor_b32 v114, v114, v16
    v_xor_b32 v115, v115, v17
    v_or3_b32 v2, v112, v113, v114
    v_bitop3_b32 v2, v2, v115, s53 bitop3:0xa8
    v_cmp_ne_u32 s[12:13], 0, v2
    s_mov_b64 exec, s[14:15]
    v_xor_b32 v116, v116, v14
    v_xor_b32 v117, v117, v15
    v_xor_b32 v118, v118, v16
    v_xor_b32 v119, v119, v17
    v_or3_b32 v2, v116, v117, v118
    v_bitop3_b32 v2, v2, v119, s53 bitop3:0xa8
    v_cmp_ne_u32 s[14:15], 0, v2
    s_mov_b64 exec, s[16:17]
    v_xor_b32 v120, v120, v14
    v_xor_b32 v121, v121, v15
    v_xor_b32 v122, v122, v16
    v_xor_b32 v123, v123, v17
    v_or3_b32 v2, v120, v121, v122
    v_bitop3_b32 v2, v2, v123, s53 bitop3:0xa8
    v_cmp_ne_u32 s[16:17], 0, v2
    s_mov_b64 exec, s[18:19]
    v_xor_b32 v124, v124, v14
    v_xor_b32 v125, v125, v15
    v_xor_b32 v126, v126, v16
    v_xor_b32 v127, v127, v17
    v_or3_b32 v2, v124, v125, v126
    v_bitop3_b32 v2, v2, v127, s53 bitop3:0xa8
    v_cmp_ne_u32 s[18:19], 0, v2
    s_mov_b64 exec, -1
    s_or_b64 vcc, s[4:5], s[6:7]
    s_or_b64 vcc, vcc, s[8:9]
    s_or_b64 vcc, vcc, s[10:11]
    s_or_b64 vcc, vcc, s[12:13]
    s_or_b64 vcc, vcc, s[14:15]
    s_or_b64 vcc, vcc, s[16:17]
    s_or_b64 vcc, vcc, s[18:19]
    s_cbranch_scc0 L_xq_recurren
    s_sleep 4
    s_sub_u32 s28, s28, 1
    s_cmp_gt_i32 s28, 0
    s_cbranch_scc1 L_gq_recurren
L_xq_recurren:
    v_add_f32 v96, v96, v104
    v_add_f32 v112, v112, v120
    v_add_f32 v97, v97, v105
    v_add_f32 v113, v113, v121
    v_add_f32 v98, v98, v106
    v_add_f32 v114, v114, v122
    v_add_f32 v99, v99, v107
    v_add_f32 v115, v115, v123
    v_add_f32 v100, v100, v108
    v_add_f32 v116, v116, v124
    v_add_f32 v101, v101, v109
    v_add_f32 v117, v117, v125
    v_add_f32 v102, v102, v110
    v_add_f32 v118, v118, v126
    v_add_f32 v103, v103, v111
    v_add_f32 v119, v119, v127
    v_add_f32 v96, v96, v112
    v_add_f32 v97, v97, v113
    v_add_f32 v98, v98, v114
    v_add_f32 v99, v99, v115
    v_add_f32 v100, v100, v116
    v_add_f32 v101, v101, v117
    v_add_f32 v102, v102, v118
    v_add_f32 v103, v103, v119
    v_cvt_pk_bf16_f32 v96, v96, v97
    ds_write_b16 v8, v96 offset:0
    ds_write_b16_d16_hi v8, v96 offset:32
    v_cvt_pk_bf16_f32 v98, v98, v99
    ds_write_b16 v8, v98 offset:64
    ds_write_b16_d16_hi v8, v98 offset:96
    v_cvt_pk_bf16_f32 v100, v100, v101
    ds_write_b16 v8, v100 offset:512
    ds_write_b16_d16_hi v8, v100 offset:544
    v_cvt_pk_bf16_f32 v102, v102, v103
    ds_write_b16 v8, v102 offset:576
    ds_write_b16_d16_hi v8, v102 offset:608
    s_waitcnt lgkmcnt(0)
    ds_write_b32 v1, v23 offset:276
    s_mov_b32 s43, 0
    s_branch L_cons_recurren
L_w2_recurren:
    v_mov_b32 v1, 0x27700
    s_load_dwordx2 s[26:27], s[0:1], 88
    s_mov_b32 s53, 0x3ff
    s_waitcnt lgkmcnt(0)
    s_mov_b32 s36, s26
    s_mov_b32 s37, s27
    s_mov_b32 s38, 0x1000000
    s_mov_b32 s39, 0x20000
L_p3_recurren:
    ds_read_b32 v2, v1 offset:276
    s_waitcnt lgkmcnt(0)
    v_readfirstlane_b32 s41, v2
    s_cmp_ge_i32 s41, 1
    s_cbranch_scc1 L_q3_recurren
    s_sleep 1
    s_sub_u32 s28, s28, 1
    s_cmp_gt_i32 s28, 0
    s_cbranch_scc1 L_p3_recurren
L_q3_recurren:
    s_waitcnt vmcnt(0)
    ds_read_b32 v18, v1 offset:280
    s_mov_b32 s43, 1
    s_waitcnt lgkmcnt(0)
    v_bfe_u32 v14, v18, 0, 10
    v_bfe_u32 v15, v18, 8, 10
    v_bfe_u32 v16, v18, 16, 10
    v_bfe_u32 v17, v18, 24, 10
L_cons_recurren:
    v_bfe_u32 v2, v0, 3, 1
    v_lshlrev_b32 v22, 9, v2
    v_lshlrev_b32 v26, 10, v2
    v_lshrrev_b32 v2, 4, v0
    v_lshl_add_u32 v22, v2, 6, v22
    v_lshlrev_b32 v5, 6, v2
    v_lshlrev_b32 v6, 9, v2
    v_and_b32 v2, 3, v0
    v_lshl_add_u32 v22, v2, 4, v22
    v_lshl_add_u32 v5, v2, 4, v5
    v_add_u32 v22, 0x20000, v22
    ds_read_b128 v[44:47], v22
    ds_read_b128 v[48:51], v22 offset:256
    v_bfe_u32 v2, v0, 2, 2
    v_lshl_add_u32 v5, v2, 9, v5
    v_and_b32 v2, 15, v0
    v_lshl_add_u32 v6, v2, 4, v6
    v_lshrrev_b32 v2, 3, v0
    v_lshlrev_b32 v40, 4, v2
    s_lshl_b32 s46, s43, 7
    s_add_u32 s46, s46, 0x20400
    v_add_u32 v40, s46, v40
    v_and_b32 v2, 1, v0
    v_mov_b32 v3, 0xffff
    v_lshlrev_b32 v2, 4, v2
    v_lshlrev_b32 v3, v2, v3
    v_bfe_u32 v2, v0, 1, 2
    v_cmp_eq_u32 vcc, 0, v2
    s_nop 1
    v_cndmask_b32 v52, 0, v3, vcc
    v_cmp_eq_u32 vcc, 1, v2
    s_nop 1
    v_cndmask_b32 v53, 0, v3, vcc
    v_cmp_eq_u32 vcc, 2, v2
    s_nop 1
    v_cndmask_b32 v54, 0, v3, vcc
    v_cmp_eq_u32 vcc, 3, v2
    s_nop 1
    v_cndmask_b32 v55, 0, v3, vcc
    v_mov_b32 v56, 0
    v_mov_b32 v57, 0
    v_mov_b32 v58, 0
    v_mov_b32 v59, 0
    v_mov_b32 v60, 0
    v_mov_b32 v61, 0
    v_mov_b32 v62, 0
    v_mov_b32 v63, 0
    v_mov_b32 v9, 0xff800000
    v_mov_b32 v11, 0
    v_mov_b32 v12, v16
    v_mov_b32 v13, v17
    v_mov_b32 v23, 0
    s_lshl_b32 s46, s43, 2
    s_add_u32 s46, s46, 0x27800
    v_mov_b32 v24, s46
    s_mov_b32 s44, 0x3db8aa3b
    s_mov_b32 s45, 0xbdb8aa3b
    s_mov_b32 s41, 0
    v_lshrrev_b32 v2, 5, v0
    v_lshlrev_b32 v25, 3, v2
    v_bfe_u32 v2, v0, 2, 2
    v_add_u32 v25, v2, v25
    v_mul_u32_u24 v25, 0x1080, v25
    v_and_b32 v2, 3, v0
    v_lshl_add_u32 v25, v2, 5, v25
    v_bfe_u32 v2, v0, 4, 1
    v_lshl_add_u32 v25, v2, 4, v25
    s_lshr_b32 s48, s98, 7
    s_lshl_b32 s48, s48, 4
    s_and_b32 s46, s98, 15
    s_add_u32 s48, s48, s46
    s_bfe_u32 s51, s98, 0x30004
    s_mul_i32 s50, s51, 0x10800
    s_mul_i32 s54, s51, 0x1100
    s_lshl_b32 s51, s51, 11
    s_lshl_b32 s46, s48, 7
    s_add_u32 s50, s50, s46
    s_add_u32 s50, s50, 0xc0000
    s_add_u32 s52, s50, 0x4200
    s_lshl_b32 s46, s48, 2
    s_add_u32 s54, s54, s46
    s_add_u32 s54, s54, 0x60200
    s_lshl_b32 s48, s48, 1
    s_add_u32 s48, s48, s43
    s_lshl_b32 s46, s48, 4
    s_add_u32 s51, s51, s46
    s_add_u32 s51, s51, 0x4000
.p2align 6
L_ck_recurren:
    s_and_b32 s46, s43, 7
    s_lshl_b32 s46, s46, 14
    v_add_u32 v7, s46, v5
    s_lshl_b32 s42, s43, 4
    s_add_u32 s42, s42, 36
    s_cmp_ge_i32 s41, s42
    s_cbranch_scc1 L_q4_recurren
L_p4_recurren:
    ds_read_b32 v2, v1 offset:0
    s_waitcnt lgkmcnt(0)
    v_readfirstlane_b32 s41, v2
    s_cmp_ge_i32 s41, s42
    s_cbranch_scc1 L_q4_recurren
    s_sleep 1
    s_sub_u32 s28, s28, 1
    s_cmp_gt_i32 s28, 0
    s_cbranch_scc1 L_p4_recurren
L_q4_recurren:
    ds_read_b128 v[96:99], v7 offset:0
    ds_read_b128 v[104:107], v7 offset:2048
    ds_read_b128 v[112:115], v7 offset:4096
    ds_read_b128 v[120:123], v7 offset:6144
    ds_read_b128 v[100:103], v7 offset:256
    ds_read_b128 v[108:111], v7 offset:2304
    ds_read_b128 v[116:119], v7 offset:4352
    ds_read_b128 v[124:127], v7 offset:6400
    s_add_u32 s42, s42, 8
    s_waitcnt lgkmcnt(7)
    v_mfma_f32_16x16x32_bf16 v[64:67], v[96:99], v[44:47], 0
    s_waitcnt lgkmcnt(6)
    v_mfma_f32_16x16x32_bf16 v[68:71], v[104:107], v[44:47], 0
    s_waitcnt lgkmcnt(5)
    v_mfma_f32_16x16x32_bf16 v[72:75], v[112:115], v[44:47], 0
    s_waitcnt lgkmcnt(4)
    v_mfma_f32_16x16x32_bf16 v[76:79], v[120:123], v[44:47], 0
    s_waitcnt lgkmcnt(3)
    v_mfma_f32_16x16x32_bf16 v[64:67], v[100:103], v[48:51], v[64:67]
    s_waitcnt lgkmcnt(2)
    v_mfma_f32_16x16x32_bf16 v[68:71], v[108:111], v[48:51], v[68:71]
    s_waitcnt lgkmcnt(1)
    v_mfma_f32_16x16x32_bf16 v[72:75], v[116:119], v[48:51], v[72:75]
    s_waitcnt lgkmcnt(0)
    v_mfma_f32_16x16x32_bf16 v[76:79], v[124:127], v[48:51], v[76:79]
    s_cmp_ge_i32 s41, s42
    s_cbranch_scc1 L_q5_recurren
L_p5_recurren:
    ds_read_b32 v2, v1 offset:0
    s_waitcnt lgkmcnt(0)
    v_readfirstlane_b32 s41, v2
    s_cmp_ge_i32 s41, s42
    s_cbranch_scc1 L_q5_recurren
    s_sleep 1
    s_sub_u32 s28, s28, 1
    s_cmp_gt_i32 s28, 0
    s_cbranch_scc1 L_p5_recurren
L_q5_recurren:
    ds_read_b128 v[128:131], v7 offset:8192
    ds_read_b128 v[136:139], v7 offset:10240
    ds_read_b128 v[144:147], v7 offset:12288
    ds_read_b128 v[152:155], v7 offset:14336
    ds_read_b128 v[132:135], v7 offset:8448
    ds_read_b128 v[140:143], v7 offset:10496
    ds_read_b128 v[148:151], v7 offset:12544
    ds_read_b128 v[156:159], v7 offset:14592
    v_add_u32 v23, 1, v23
    s_waitcnt lgkmcnt(7)
    v_mfma_f32_16x16x32_bf16 v[80:83], v[128:131], v[44:47], 0
    s_waitcnt lgkmcnt(6)
    v_mfma_f32_16x16x32_bf16 v[84:87], v[136:139], v[44:47], 0
    s_waitcnt lgkmcnt(5)
    v_mfma_f32_16x16x32_bf16 v[88:91], v[144:147], v[44:47], 0
    s_waitcnt lgkmcnt(4)
    v_mfma_f32_16x16x32_bf16 v[92:95], v[152:155], v[44:47], 0
    s_waitcnt lgkmcnt(3)
    v_mfma_f32_16x16x32_bf16 v[80:83], v[132:135], v[48:51], v[80:83]
    s_waitcnt lgkmcnt(2)
    v_mfma_f32_16x16x32_bf16 v[84:87], v[140:143], v[48:51], v[84:87]
    s_waitcnt lgkmcnt(1)
    v_mfma_f32_16x16x32_bf16 v[88:91], v[148:151], v[48:51], v[88:91]
    s_waitcnt lgkmcnt(0)
    v_mfma_f32_16x16x32_bf16 v[92:95], v[156:159], v[48:51], v[92:95]
    ds_write_b32 v24, v23
    v_mov_b32_dpp v28, v64 quad_perm:[0,0,0,0] row_mask:0xf bank_mask:0xf
    v_mov_b32_dpp v29, v68 quad_perm:[0,0,0,0] row_mask:0xf bank_mask:0xf
    v_mov_b32_dpp v30, v72 quad_perm:[0,0,0,0] row_mask:0xf bank_mask:0xf
    v_mov_b32_dpp v31, v76 quad_perm:[0,0,0,0] row_mask:0xf bank_mask:0xf
    v_mov_b32_dpp v32, v80 quad_perm:[0,0,0,0] row_mask:0xf bank_mask:0xf
    v_mov_b32_dpp v33, v84 quad_perm:[0,0,0,0] row_mask:0xf bank_mask:0xf
    v_mov_b32_dpp v34, v88 quad_perm:[0,0,0,0] row_mask:0xf bank_mask:0xf
    v_mov_b32_dpp v35, v92 quad_perm:[0,0,0,0] row_mask:0xf bank_mask:0xf
    v_add_f32_dpp v28, v65, v28 quad_perm:[1,1,1,1] row_mask:0xf bank_mask:0xf
    v_add_f32_dpp v29, v69, v29 quad_perm:[1,1,1,1] row_mask:0xf bank_mask:0xf
    v_add_f32_dpp v30, v73, v30 quad_perm:[1,1,1,1] row_mask:0xf bank_mask:0xf
    v_add_f32_dpp v31, v77, v31 quad_perm:[1,1,1,1] row_mask:0xf bank_mask:0xf
    v_add_f32_dpp v32, v81, v32 quad_perm:[1,1,1,1] row_mask:0xf bank_mask:0xf
    v_add_f32_dpp v33, v85, v33 quad_perm:[1,1,1,1] row_mask:0xf bank_mask:0xf
    v_add_f32_dpp v34, v89, v34 quad_perm:[1,1,1,1] row_mask:0xf bank_mask:0xf
    v_add_f32_dpp v35, v93, v35 quad_perm:[1,1,1,1] row_mask:0xf bank_mask:0xf
    v_add_f32_dpp v28, v66, v28 quad_perm:[2,2,2,2] row_mask:0xf bank_mask:0xf
    v_add_f32_dpp v29, v70, v29 quad_perm:[2,2,2,2] row_mask:0xf bank_mask:0xf
    v_add_f32_dpp v30, v74, v30 quad_perm:[2,2,2,2] row_mask:0xf bank_mask:0xf
    v_add_f32_dpp v31, v78, v31 quad_perm:[2,2,2,2] row_mask:0xf bank_mask:0xf
    v_add_f32_dpp v32, v82, v32 quad_perm:[2,2,2,2] row_mask:0xf bank_mask:0xf
    v_add_f32_dpp v33, v86, v33 quad_perm:[2,2,2,2] row_mask:0xf bank_mask:0xf
    v_add_f32_dpp v34, v90, v34 quad_perm:[2,2,2,2] row_mask:0xf bank_mask:0xf
    v_add_f32_dpp v35, v94, v35 quad_perm:[2,2,2,2] row_mask:0xf bank_mask:0xf
    v_add_f32_dpp v28, v67, v28 quad_perm:[3,3,3,3] row_mask:0xf bank_mask:0xf
    v_add_f32_dpp v29, v71, v29 quad_perm:[3,3,3,3] row_mask:0xf bank_mask:0xf
    v_add_f32_dpp v30, v75, v30 quad_perm:[3,3,3,3] row_mask:0xf bank_mask:0xf
    v_add_f32_dpp v31, v79, v31 quad_perm:[3,3,3,3] row_mask:0xf bank_mask:0xf
    v_add_f32_dpp v32, v83, v32 quad_perm:[3,3,3,3] row_mask:0xf bank_mask:0xf
    v_add_f32_dpp v33, v87, v33 quad_perm:[3,3,3,3] row_mask:0xf bank_mask:0xf
    v_add_f32_dpp v34, v91, v34 quad_perm:[3,3,3,3] row_mask:0xf bank_mask:0xf
    v_add_f32_dpp v35, v95, v35 quad_perm:[3,3,3,3] row_mask:0xf bank_mask:0xf
    v_cvt_pk_bf16_f32 v36, v28, v29
    v_cvt_pk_bf16_f32 v37, v30, v31
    v_cvt_pk_bf16_f32 v38, v32, v33
    v_cvt_pk_bf16_f32 v39, v34, v35
    s_mov_b32 exec_lo, 0x1010101
    s_mov_b32 exec_hi, 0x1010101
    ds_write_b128 v40, v[36:39]
    s_mov_b64 exec, -1
    v_lshlrev_b32 v28, 16, v36
    v_and_b32 v29, 0xffff0000, v36
    v_lshlrev_b32 v30, 16, v37
    v_and_b32 v31, 0xffff0000, v37
    v_lshlrev_b32 v32, 16, v38
    v_and_b32 v33, 0xffff0000, v38
    v_lshlrev_b32 v34, 16, v39
    v_and_b32 v35, 0xffff0000, v39
    v_max3_f32 v22, v9, v28, v29
    v_max3_f32 v22, v22, v30, v31
    v_max3_f32 v22, v22, v32, v33
    v_max3_f32 v22, v22, v34, v35
    v_add_u32 v40, 0x100, v40
    v_mul_f32 v19, s45, v22
    v_fma_f32 v20, v9, s44, v19
    v_fma_f32 v28, v28, s44, v19
    v_fma_f32 v29, v29, s44, v19
    v_fma_f32 v30, v30, s44, v19
    v_fma_f32 v31, v31, s44, v19
    v_fma_f32 v32, v32, s44, v19
    v_fma_f32 v33, v33, s44, v19
    v_fma_f32 v34, v34, s44, v19
    v_fma_f32 v35, v35, s44, v19
    v_exp_f32 v20, v20
    v_exp_f32 v28, v28
    v_exp_f32 v29, v29
    v_exp_f32 v30, v30
    v_exp_f32 v31, v31
    v_exp_f32 v32, v32
    v_exp_f32 v33, v33
    v_exp_f32 v34, v34
    v_exp_f32 v35, v35
    v_mov_b32 v9, v22
    v_add_f32 v28, v28, v29
    v_add_f32 v30, v30, v31
    v_add_f32 v32, v32, v33
    v_add_f32 v34, v34, v35
    v_add_f32 v28, v28, v30
    v_add_f32 v32, v32, v34
    v_add_f32 v28, v28, v32
    s_add_u32 s43, s43, 2
    v_fma_f32 v11, v11, v20, v28
    s_cmp_lt_u32 s43, 64
    s_cbranch_scc1 L_ck_recurren
    v_mov_b32 v2, v22
    s_nop 1
    v_permlane16_swap_b32 v22, v2
    v_max_f32 v22, v22, v2
    v_mov_b32 v2, v22
    s_nop 1
    v_permlane32_swap_b32 v22, v2
    v_max_f32 v22, v22, v2
    v_mul_f32 v19, s45, v22
    v_fma_f32 v20, v9, s44, v19
    v_exp_f32 v20, v20
    v_subrev_u32 v40, 0x2000, v40
    v_mul_f32 v11, v11, v20
    v_mov_b32 v2, v11
    s_nop 1
    v_permlane16_swap_b32 v11, v2
    v_add_f32 v11, v11, v2
    v_mov_b32 v2, v11
    s_nop 1
    v_permlane32_swap_b32 v11, v2
    v_add_f32 v11, v11, v2
    v_bfi_b32 v10, s53, v14, v22
    v_bfi_b32 v11, s53, v15, v11
    v_mov_b32 v9, v22
    s_mov_b32 exec_lo, 0x101
    s_mov_b32 exec_hi, 0x0
    buffer_store_dwordx4 v[10:13], v26, s[36:39], s51 offen sc1
    s_mov_b64 exec, -1
    v_mov_b32_dpp v9, v22 row_ror:8 row_mask:0x3 bank_mask:0xc
    s_nop 1
    v_mov_b32_dpp v9, v22 row_ror:8 row_mask:0xc bank_mask:0x3
.p2align 6
L_cv_recurren:
    ds_read_b128 v[36:39], v40
    s_and_b32 s46, s43, 7
    s_lshl_b32 s46, s46, 14
    v_add_u32 v7, s46, v6
    s_lshl_b32 s42, s43, 4
    s_add_u32 s42, s42, 36
    v_add_u32 v40, 0x100, v40
    s_waitcnt lgkmcnt(0)
    v_lshlrev_b32 v28, 16, v36
    v_and_b32 v29, 0xffff0000, v36
    v_lshlrev_b32 v30, 16, v37
    v_and_b32 v31, 0xffff0000, v37
    v_lshlrev_b32 v32, 16, v38
    v_and_b32 v33, 0xffff0000, v38
    v_lshlrev_b32 v34, 16, v39
    v_and_b32 v35, 0xffff0000, v39
    v_fma_f32 v28, v28, s44, v19
    v_fma_f32 v29, v29, s44, v19
    v_fma_f32 v30, v30, s44, v19
    v_fma_f32 v31, v31, s44, v19
    v_fma_f32 v32, v32, s44, v19
    v_fma_f32 v33, v33, s44, v19
    v_fma_f32 v34, v34, s44, v19
    v_fma_f32 v35, v35, s44, v19
    v_exp_f32 v28, v28
    v_exp_f32 v29, v29
    v_exp_f32 v30, v30
    v_exp_f32 v31, v31
    v_exp_f32 v32, v32
    v_exp_f32 v33, v33
    v_exp_f32 v34, v34
    v_exp_f32 v35, v35
    v_cvt_pk_bf16_f32 v28, v28, v28
    v_cvt_pk_bf16_f32 v29, v29, v29
    v_cvt_pk_bf16_f32 v30, v30, v30
    v_cvt_pk_bf16_f32 v31, v31, v31
    v_cvt_pk_bf16_f32 v32, v32, v32
    v_cvt_pk_bf16_f32 v33, v33, v33
    v_cvt_pk_bf16_f32 v34, v34, v34
    v_cvt_pk_bf16_f32 v35, v35, v35
    v_and_b32 v64, v28, v52
    v_and_b32 v65, v28, v53
    v_and_b32 v66, v28, v54
    v_and_b32 v67, v28, v55
    v_and_b32 v68, v29, v52
    v_and_b32 v69, v29, v53
    v_and_b32 v70, v29, v54
    v_and_b32 v71, v29, v55
    v_and_b32 v72, v30, v52
    v_and_b32 v73, v30, v53
    v_and_b32 v74, v30, v54
    v_and_b32 v75, v30, v55
    v_and_b32 v76, v31, v52
    v_and_b32 v77, v31, v53
    v_and_b32 v78, v31, v54
    v_and_b32 v79, v31, v55
    v_and_b32 v80, v32, v52
    v_and_b32 v81, v32, v53
    v_and_b32 v82, v32, v54
    v_and_b32 v83, v32, v55
    v_and_b32 v84, v33, v52
    v_and_b32 v85, v33, v53
    v_and_b32 v86, v33, v54
    v_and_b32 v87, v33, v55
    v_and_b32 v88, v34, v52
    v_and_b32 v89, v34, v53
    v_and_b32 v90, v34, v54
    v_and_b32 v91, v34, v55
    v_and_b32 v92, v35, v52
    v_and_b32 v93, v35, v53
    v_and_b32 v94, v35, v54
    v_and_b32 v95, v35, v55
    s_cmp_ge_i32 s41, s42
    s_cbranch_scc1 L_q6_recurren
L_p6_recurren:
    ds_read_b32 v2, v1 offset:0
    s_waitcnt lgkmcnt(0)
    v_readfirstlane_b32 s41, v2
    s_cmp_ge_i32 s41, s42
    s_cbranch_scc1 L_q6_recurren
    s_sleep 1
    s_sub_u32 s28, s28, 1
    s_cmp_gt_i32 s28, 0
    s_cbranch_scc1 L_p6_recurren
L_q6_recurren:
    ds_read_b128 v[96:99], v7 offset:0
    ds_read_b128 v[100:103], v7 offset:256
    ds_read_b128 v[104:107], v7 offset:2048
    ds_read_b128 v[108:111], v7 offset:2304
    ds_read_b128 v[112:115], v7 offset:4096
    ds_read_b128 v[116:119], v7 offset:4352
    ds_read_b128 v[120:123], v7 offset:6144
    ds_read_b128 v[124:127], v7 offset:6400
    s_add_u32 s42, s42, 8
    s_waitcnt lgkmcnt(7)
    v_mfma_f32_16x16x32_bf16 v[56:59], v[64:67], v[96:99], v[56:59]
    s_waitcnt lgkmcnt(6)
    v_mfma_f32_16x16x32_bf16 v[60:63], v[64:67], v[100:103], v[60:63]
    s_waitcnt lgkmcnt(5)
    v_mfma_f32_16x16x32_bf16 v[56:59], v[68:71], v[104:107], v[56:59]
    s_waitcnt lgkmcnt(4)
    v_mfma_f32_16x16x32_bf16 v[60:63], v[68:71], v[108:111], v[60:63]
    s_waitcnt lgkmcnt(3)
    v_mfma_f32_16x16x32_bf16 v[56:59], v[72:75], v[112:115], v[56:59]
    s_waitcnt lgkmcnt(2)
    v_mfma_f32_16x16x32_bf16 v[60:63], v[72:75], v[116:119], v[60:63]
    s_waitcnt lgkmcnt(1)
    v_mfma_f32_16x16x32_bf16 v[56:59], v[76:79], v[120:123], v[56:59]
    s_waitcnt lgkmcnt(0)
    v_mfma_f32_16x16x32_bf16 v[60:63], v[76:79], v[124:127], v[60:63]
    s_cmp_ge_i32 s41, s42
    s_cbranch_scc1 L_q7_recurren
L_p7_recurren:
    ds_read_b32 v2, v1 offset:0
    s_waitcnt lgkmcnt(0)
    v_readfirstlane_b32 s41, v2
    s_cmp_ge_i32 s41, s42
    s_cbranch_scc1 L_q7_recurren
    s_sleep 1
    s_sub_u32 s28, s28, 1
    s_cmp_gt_i32 s28, 0
    s_cbranch_scc1 L_p7_recurren
L_q7_recurren:
    ds_read_b128 v[128:131], v7 offset:8192
    ds_read_b128 v[132:135], v7 offset:8448
    ds_read_b128 v[136:139], v7 offset:10240
    ds_read_b128 v[140:143], v7 offset:10496
    ds_read_b128 v[144:147], v7 offset:12288
    ds_read_b128 v[148:151], v7 offset:12544
    ds_read_b128 v[152:155], v7 offset:14336
    ds_read_b128 v[156:159], v7 offset:14592
    v_add_u32 v23, 1, v23
    s_waitcnt lgkmcnt(7)
    v_mfma_f32_16x16x32_bf16 v[56:59], v[80:83], v[128:131], v[56:59]
    s_waitcnt lgkmcnt(6)
    v_mfma_f32_16x16x32_bf16 v[60:63], v[80:83], v[132:135], v[60:63]
    s_waitcnt lgkmcnt(5)
    v_mfma_f32_16x16x32_bf16 v[56:59], v[84:87], v[136:139], v[56:59]
    s_waitcnt lgkmcnt(4)
    v_mfma_f32_16x16x32_bf16 v[60:63], v[84:87], v[140:143], v[60:63]
    s_waitcnt lgkmcnt(3)
    v_mfma_f32_16x16x32_bf16 v[56:59], v[88:91], v[144:147], v[56:59]
    s_waitcnt lgkmcnt(2)
    v_mfma_f32_16x16x32_bf16 v[60:63], v[88:91], v[148:151], v[60:63]
    s_waitcnt lgkmcnt(1)
    v_mfma_f32_16x16x32_bf16 v[56:59], v[92:95], v[152:155], v[56:59]
    s_waitcnt lgkmcnt(0)
    v_mfma_f32_16x16x32_bf16 v[60:63], v[92:95], v[156:159], v[60:63]
    ds_write_b32 v24, v23
    s_add_u32 s43, s43, 2
    s_cmp_lt_u32 s43, 126
    s_cbranch_scc1 L_cv_recurren
L_p8_recurren:
    ds_read_b32 v2, v1 offset:284
    s_waitcnt lgkmcnt(0)
    v_readfirstlane_b32 s47, v2
    s_cmp_ge_i32 s47, 1
    s_cbranch_scc1 L_q8_recurren
    s_sleep 1
    s_sub_u32 s28, s28, 1
    s_cmp_gt_i32 s28, 0
    s_cbranch_scc1 L_p8_recurren
L_q8_recurren:
    v_lshrrev_b32 v2, 5, v0
    v_lshl_add_u32 v2, v2, 3, v1
    ds_read_b64 v[36:37], v2 offset:288
    v_bfe_u32 v3, v0, 3, 1
    v_lshl_add_u32 v3, v3, 3, v1
    ds_read_b64 v[38:39], v3 offset:288
    s_waitcnt lgkmcnt(0)
    v_sub_f32 v20, v9, v36
    v_log_f32 v19, v39
    v_mul_f32 v20, s44, v20
    v_exp_f32 v20, v20
    v_fmac_f32 v19, s45, v38
    v_mul_f32 v20, v20, v37
    v_mul_f32 v56, v56, v20
    v_mul_f32 v57, v57, v20
    v_mul_f32 v58, v58, v20
    v_mul_f32 v59, v59, v20
    v_mul_f32 v60, v60, v20
    v_mul_f32 v61, v61, v20
    v_mul_f32 v62, v62, v20
    v_mul_f32 v63, v63, v20
    v_lshlrev_b32 v8, 4, v0
    v_add_u32 v8, 0x23800, v8
    ds_read_b128 v[36:39], v40
    s_and_b32 s46, s43, 7
    s_lshl_b32 s46, s46, 14
    v_add_u32 v7, s46, v6
    s_lshl_b32 s42, s43, 4
    s_add_u32 s42, s42, 36
    v_add_u32 v40, 0x100, v40
    s_waitcnt lgkmcnt(0)
    v_lshlrev_b32 v28, 16, v36
    v_and_b32 v29, 0xffff0000, v36
    v_lshlrev_b32 v30, 16, v37
    v_and_b32 v31, 0xffff0000, v37
    v_lshlrev_b32 v32, 16, v38
    v_and_b32 v33, 0xffff0000, v38
    v_lshlrev_b32 v34, 16, v39
    v_and_b32 v35, 0xffff0000, v39
    v_fma_f32 v28, v28, s44, v19
    v_fma_f32 v29, v29, s44, v19
    v_fma_f32 v30, v30, s44, v19
    v_fma_f32 v31, v31, s44, v19
    v_fma_f32 v32, v32, s44, v19
    v_fma_f32 v33, v33, s44, v19
    v_fma_f32 v34, v34, s44, v19
    v_fma_f32 v35, v35, s44, v19
    v_exp_f32 v28, v28
    v_exp_f32 v29, v29
    v_exp_f32 v30, v30
    v_exp_f32 v31, v31
    v_exp_f32 v32, v32
    v_exp_f32 v33, v33
    v_exp_f32 v34, v34
    v_exp_f32 v35, v35
    v_cvt_pk_bf16_f32 v28, v28, v28
    v_cvt_pk_bf16_f32 v29, v29, v29
    v_cvt_pk_bf16_f32 v30, v30, v30
    v_cvt_pk_bf16_f32 v31, v31, v31
    v_cvt_pk_bf16_f32 v32, v32, v32
    v_cvt_pk_bf16_f32 v33, v33, v33
    v_cvt_pk_bf16_f32 v34, v34, v34
    v_cvt_pk_bf16_f32 v35, v35, v35
    v_and_b32 v64, v28, v52
    v_and_b32 v65, v28, v53
    v_and_b32 v66, v28, v54
    v_and_b32 v67, v28, v55
    v_and_b32 v68, v29, v52
    v_and_b32 v69, v29, v53
    v_and_b32 v70, v29, v54
    v_and_b32 v71, v29, v55
    v_and_b32 v72, v30, v52
    v_and_b32 v73, v30, v53
    v_and_b32 v74, v30, v54
    v_and_b32 v75, v30, v55
    v_and_b32 v76, v31, v52
    v_and_b32 v77, v31, v53
    v_and_b32 v78, v31, v54
    v_and_b32 v79, v31, v55
    v_and_b32 v80, v32, v52
    v_and_b32 v81, v32, v53
    v_and_b32 v82, v32, v54
    v_and_b32 v83, v32, v55
    v_and_b32 v84, v33, v52
    v_and_b32 v85, v33, v53
    v_and_b32 v86, v33, v54
    v_and_b32 v87, v33, v55
    v_and_b32 v88, v34, v52
    v_and_b32 v89, v34, v53
    v_and_b32 v90, v34, v54
    v_and_b32 v91, v34, v55
    v_and_b32 v92, v35, v52
    v_and_b32 v93, v35, v53
    v_and_b32 v94, v35, v54
    v_and_b32 v95, v35, v55
    s_cmp_ge_i32 s41, s42
    s_cbranch_scc1 L_q9_recurren
L_p9_recurren:
    ds_read_b32 v2, v1 offset:0
    s_waitcnt lgkmcnt(0)
    v_readfirstlane_b32 s41, v2
    s_cmp_ge_i32 s41, s42
    s_cbranch_scc1 L_q9_recurren
    s_sub_u32 s28, s28, 1
    s_cmp_gt_i32 s28, 0
    s_cbranch_scc1 L_p9_recurren
L_q9_recurren:
    ds_read_b128 v[96:99], v7 offset:0
    ds_read_b128 v[100:103], v7 offset:256
    ds_read_b128 v[104:107], v7 offset:2048
    ds_read_b128 v[108:111], v7 offset:2304
    ds_read_b128 v[112:115], v7 offset:4096
    ds_read_b128 v[116:119], v7 offset:4352
    ds_read_b128 v[120:123], v7 offset:6144
    ds_read_b128 v[124:127], v7 offset:6400
    s_add_u32 s42, s42, 4
    s_waitcnt lgkmcnt(7)
    v_mfma_f32_16x16x32_bf16 v[56:59], v[64:67], v[96:99], v[56:59]
    s_waitcnt lgkmcnt(6)
    v_mfma_f32_16x16x32_bf16 v[60:63], v[64:67], v[100:103], v[60:63]
    s_waitcnt lgkmcnt(5)
    v_mfma_f32_16x16x32_bf16 v[56:59], v[68:71], v[104:107], v[56:59]
    s_waitcnt lgkmcnt(4)
    v_mfma_f32_16x16x32_bf16 v[60:63], v[68:71], v[108:111], v[60:63]
    s_waitcnt lgkmcnt(3)
    v_mfma_f32_16x16x32_bf16 v[56:59], v[72:75], v[112:115], v[56:59]
    s_waitcnt lgkmcnt(2)
    v_mfma_f32_16x16x32_bf16 v[60:63], v[72:75], v[116:119], v[60:63]
    s_waitcnt lgkmcnt(1)
    v_mfma_f32_16x16x32_bf16 v[56:59], v[76:79], v[120:123], v[56:59]
    s_waitcnt lgkmcnt(0)
    v_mfma_f32_16x16x32_bf16 v[60:63], v[76:79], v[124:127], v[60:63]
    s_cmp_ge_i32 s41, s42
    s_cbranch_scc1 L_q10_recurren
L_p10_recurren:
    ds_read_b32 v2, v1 offset:0
    s_waitcnt lgkmcnt(0)
    v_readfirstlane_b32 s41, v2
    s_cmp_ge_i32 s41, s42
    s_cbranch_scc1 L_q10_recurren
    s_sub_u32 s28, s28, 1
    s_cmp_gt_i32 s28, 0
    s_cbranch_scc1 L_p10_recurren
L_q10_recurren:
    ds_read_b128 v[128:131], v7 offset:8192
    ds_read_b128 v[132:135], v7 offset:8448
    ds_read_b128 v[136:139], v7 offset:10240
    ds_read_b128 v[140:143], v7 offset:10496
    s_add_u32 s42, s42, 4
    s_waitcnt lgkmcnt(3)
    v_mfma_f32_16x16x32_bf16 v[56:59], v[80:83], v[128:131], v[56:59]
    s_waitcnt lgkmcnt(2)
    v_mfma_f32_16x16x32_bf16 v[60:63], v[80:83], v[132:135], v[60:63]
    s_waitcnt lgkmcnt(1)
    v_mfma_f32_16x16x32_bf16 v[56:59], v[84:87], v[136:139], v[56:59]
    s_waitcnt lgkmcnt(0)
    v_mfma_f32_16x16x32_bf16 v[60:63], v[84:87], v[140:143], v[60:63]
    s_cmp_eq_u32 s3, 1
    s_cbranch_scc1 L_nadd_recurren
L_p11_recurren:
    ds_read_b32 v2, v1 offset:272
    s_waitcnt lgkmcnt(0)
    v_readfirstlane_b32 s47, v2
    s_cmp_ge_i32 s47, 1
    s_cbranch_scc1 L_q11_recurren
    s_sub_u32 s28, s28, 1
    s_cmp_gt_i32 s28, 0
    s_cbranch_scc1 L_p11_recurren
L_q11_recurren:
    ds_read_b128 v[96:99], v8
    ds_read_b128 v[100:103], v8 offset:1024
    s_waitcnt lgkmcnt(0)
    v_add_f32 v56, v56, v96
    v_add_f32 v57, v57, v97
    v_add_f32 v58, v58, v98
    v_add_f32 v59, v59, v99
    v_add_f32 v60, v60, v100
    v_add_f32 v61, v61, v101
    v_add_f32 v62, v62, v102
    v_add_f32 v63, v63, v103
    s_nop 0
L_nadd_recurren:
    s_cmp_ge_i32 s41, s42
    s_cbranch_scc1 L_q12_recurren
L_p12_recurren:
    ds_read_b32 v2, v1 offset:0
    s_waitcnt lgkmcnt(0)
    v_readfirstlane_b32 s41, v2
    s_cmp_ge_i32 s41, s42
    s_cbranch_scc1 L_q12_recurren
    s_sub_u32 s28, s28, 1
    s_cmp_gt_i32 s28, 0
    s_cbranch_scc1 L_p12_recurren
L_q12_recurren:
    ds_read_b128 v[144:147], v7 offset:12288
    ds_read_b128 v[148:151], v7 offset:12544
    ds_read_b128 v[152:155], v7 offset:14336
    ds_read_b128 v[156:159], v7 offset:14592
    s_waitcnt lgkmcnt(3)
    v_mfma_f32_16x16x32_bf16 v[56:59], v[88:91], v[144:147], v[56:59]
    s_waitcnt lgkmcnt(2)
    v_mfma_f32_16x16x32_bf16 v[60:63], v[88:91], v[148:151], v[60:63]
    s_waitcnt lgkmcnt(1)
    v_mfma_f32_16x16x32_bf16 v[56:59], v[92:95], v[152:155], v[56:59]
    s_waitcnt lgkmcnt(0)
    v_mfma_f32_16x16x32_bf16 v[60:63], v[92:95], v[156:159], v[60:63]
    s_cmp_eq_u32 s3, 1
    s_cbranch_scc1 L_c0e_recurren
    s_mov_b64 exec, 1
    buffer_store_dword v18, v26, s[36:39], s54 offen
    s_nop 1
    s_mov_b64 exec, -1
    v_bfi_b32 v56, s53, v14, v56
    v_bfi_b32 v57, s53, v15, v57
    v_bfi_b32 v58, s53, v16, v58
    v_bfi_b32 v59, s53, v17, v59
    buffer_store_dwordx4 v[56:59], v25, s[36:39], s50 offen sc1
    v_bfi_b32 v60, s53, v14, v60
    v_bfi_b32 v61, s53, v15, v61
    v_bfi_b32 v62, s53, v16, v62
    v_bfi_b32 v63, s53, v17, v63
    buffer_store_dwordx4 v[60:63], v25, s[36:39], s52 offen sc1
    s_branch L_cend_recurren
L_c0e_recurren:
    v_mov_b32 v2, 1
    s_nop 3
    ds_write_b128 v8, v[56:59]
    ds_write_b128 v8, v[60:63] offset:1024
    s_waitcnt lgkmcnt(0)
    ds_write_b32 v1, v2 offset:272
L_cend_recurren:
    s_endpgm
L_w3_recurren:
    v_mov_b32 v1, 0x27700
    v_lshrrev_b32 v2, 4, v0
    v_and_b32 v3, 15, v0
    v_mul_u32_u24 v9, 3584, v2
    v_lshl_add_u32 v9, v3, 4, v9
    v_lshlrev_b32 v10, 5, v3
    v_lshlrev_b32 v12, 7, v3
    v_lshl_add_u32 v12, v2, 4, v12
    v_lshlrev_b32 v13, 4, v3
    v_bfe_u32 v3, v0, 4, 1
    v_lshl_add_u32 v10, v3, 4, v10
    v_lshrrev_b32 v3, 5, v0
    v_mul_u32_u24 v3, 1792, v3
    v_add_u32 v10, v3, v10
    v_lshlrev_b32 v11, 7, v0
    v_and_b32 v2, 1, v0
    v_mov_b32 v3, 0xffff
    v_lshlrev_b32 v2, 4, v2
    v_lshlrev_b32 v3, v2, v3
    v_bfe_u32 v2, v0, 1, 2
    v_cmp_eq_u32 vcc, 0, v2
    s_nop 1
    v_cndmask_b32 v16, 0, v3, vcc
    v_cmp_eq_u32 vcc, 1, v2
    s_nop 1
    v_cndmask_b32 v17, 0, v3, vcc
    v_cmp_eq_u32 vcc, 2, v2
    s_nop 1
    v_cndmask_b32 v18, 0, v3, vcc
    v_cmp_eq_u32 vcc, 3, v2
    s_nop 1
    v_cndmask_b32 v19, 0, v3, vcc
    s_and_b32 s58, s2, 7
    s_lshr_b32 s59, s2, 3
    s_mul_i32 s57, s58, 28
    s_add_u32 s57, s57, s59
    s_mov_b32 s61, 0x3ff
    s_barrier
    s_waitcnt lgkmcnt(0)
    s_mov_b32 s32, s4
    s_mov_b32 s33, s5
    s_mov_b32 s34, 0x700
    s_mov_b32 s35, 0x20000
    s_mov_b32 s36, s26
    s_mov_b32 s37, s27
    s_mov_b32 s38, 0x1000000
    s_mov_b32 s39, 0x20000
    s_mov_b32 s44, s12
    s_mov_b32 s45, s13
    s_mov_b32 s46, 0x380000
    s_mov_b32 s47, 0x20000
    s_mov_b32 s52, s22
    s_mov_b32 s53, s23
    s_mov_b32 s54, 0x700
    s_mov_b32 s55, 0x20000
    s_and_b32 s48, s2, 7
    s_lshl_b32 s48, s48, 4
    s_lshr_b32 s58, s2, 4
    s_add_u32 s48, s48, s58
    s_cmp_lt_u32 s2, 200
    s_cbranch_scc1 L_nwd_recurren
    s_mov_b32 s40, s20
    s_mov_b32 s41, s21
    s_mov_b32 s42, 0x188000
    s_mov_b32 s43, 0x20000
    s_sub_u32 s58, s2, 200
    s_mul_i32 s58, s58, 0x7000
L_p13_recurren:
    ds_read_b32 v2, v1 offset:0
    s_waitcnt lgkmcnt(0)
    v_readfirstlane_b32 s56, v2
    s_cmp_ge_i32 s56, 30
    s_cbranch_scc1 L_q13_recurren
    s_sleep 1
    s_sub_u32 s28, s28, 1
    s_cmp_gt_i32 s28, 0
    s_cbranch_scc1 L_p13_recurren
L_q13_recurren:
    buffer_load_dwordx4 a[0:3], v9, s[40:43], s58 offen offset:0 nt
    buffer_load_dwordx4 a[16:19], v9, s[40:43], s58 offen offset:896 nt
    buffer_load_dwordx4 a[32:35], v9, s[40:43], s58 offen offset:1792 nt
    buffer_load_dwordx4 a[48:51], v9, s[40:43], s58 offen offset:2688 nt
    buffer_load_dwordx4 a[4:7], v9, s[40:43], s58 offen offset:256 nt
    buffer_load_dwordx4 a[20:23], v9, s[40:43], s58 offen offset:1152 nt
    buffer_load_dwordx4 a[36:39], v9, s[40:43], s58 offen offset:2048 nt
    buffer_load_dwordx4 a[52:55], v9, s[40:43], s58 offen offset:2944 nt
    buffer_load_dwordx4 a[8:11], v9, s[40:43], s58 offen offset:512 nt
    buffer_load_dwordx4 a[24:27], v9, s[40:43], s58 offen offset:1408 nt
    buffer_load_dwordx4 a[40:43], v9, s[40:43], s58 offen offset:2304 nt
    buffer_load_dwordx4 a[56:59], v9, s[40:43], s58 offen offset:3200 nt
    s_mov_b32 exec_lo, 0xff00ff
    s_mov_b32 exec_hi, 0xff00ff
    buffer_load_dwordx4 a[12:15], v9, s[40:43], s58 offen offset:768 nt
    buffer_load_dwordx4 a[28:31], v9, s[40:43], s58 offen offset:1664 nt
    buffer_load_dwordx4 a[44:47], v9, s[40:43], s58 offen offset:2560 nt
    buffer_load_dwordx4 a[60:63], v9, s[40:43], s58 offen offset:3456 nt
    s_mov_b64 exec, -1
    s_add_u32 s58, s58, 0x3800
    buffer_load_dwordx4 a[64:67], v9, s[40:43], s58 offen offset:0 nt
    buffer_load_dwordx4 a[80:83], v9, s[40:43], s58 offen offset:896 nt
    buffer_load_dwordx4 a[96:99], v9, s[40:43], s58 offen offset:1792 nt
    buffer_load_dwordx4 a[112:115], v9, s[40:43], s58 offen offset:2688 nt
    buffer_load_dwordx4 a[68:71], v9, s[40:43], s58 offen offset:256 nt
    buffer_load_dwordx4 a[84:87], v9, s[40:43], s58 offen offset:1152 nt
    buffer_load_dwordx4 a[100:103], v9, s[40:43], s58 offen offset:2048 nt
    buffer_load_dwordx4 a[116:119], v9, s[40:43], s58 offen offset:2944 nt
    buffer_load_dwordx4 a[72:75], v9, s[40:43], s58 offen offset:512 nt
    buffer_load_dwordx4 a[88:91], v9, s[40:43], s58 offen offset:1408 nt
    buffer_load_dwordx4 a[104:107], v9, s[40:43], s58 offen offset:2304 nt
    buffer_load_dwordx4 a[120:123], v9, s[40:43], s58 offen offset:3200 nt
    s_mov_b32 exec_lo, 0xff00ff
    s_mov_b32 exec_hi, 0xff00ff
    buffer_load_dwordx4 a[76:79], v9, s[40:43], s58 offen offset:768 nt
    buffer_load_dwordx4 a[92:95], v9, s[40:43], s58 offen offset:1664 nt
    buffer_load_dwordx4 a[108:111], v9, s[40:43], s58 offen offset:2560 nt
    buffer_load_dwordx4 a[124:127], v9, s[40:43], s58 offen offset:3456 nt
    s_mov_b64 exec, -1
    s_add_u32 s58, s58, 0x3800
L_nwd_recurren:
L_p14_recurren:
    ds_read_b32 v2, v1 offset:276
    s_waitcnt lgkmcnt(0)
    v_readfirstlane_b32 s56, v2
    s_cmp_ge_i32 s56, 1
    s_cbranch_scc1 L_q14_recurren
    s_sleep 1
    s_sub_u32 s28, s28, 1
    s_cmp_gt_i32 s28, 0
    s_cbranch_scc1 L_p14_recurren
L_q14_recurren:
    ds_read_b32 v28, v1 offset:280
    s_waitcnt lgkmcnt(0)
    v_bfe_u32 v24, v28, 0, 10
    v_bfe_u32 v25, v28, 8, 10
    v_bfe_u32 v26, v28, 16, 10
    v_bfe_u32 v27, v28, 24, 10
    s_cmp_ge_u32 s2, 224
    s_cbranch_scc1 L_nof1_recurren
    s_and_b32 s58, s2, 3
    s_mul_i32 s58, s58, 224
    s_add_u32 s58, s58, 0x27000
    v_and_b32 v2, 1, v0
    v_mul_u32_u24 v5, 896, v2
    v_add_u32 v5, s58, v5
    v_bfe_u32 v2, v0, 2, 2
    v_lshlrev_b32 v7, 7, v2
    v_and_b32 v2, 3, v0
    v_lshl_add_u32 v7, v2, 3, v7
    v_add_u32 v7, 0x23800, v7
    v_lshrrev_b32 v2, 4, v0
    v_lshl_add_u32 v6, v2, 3, v5
    v_lshl_add_u32 v5, v2, 4, v5
    v_lshl_add_u32 v8, v2, 9, v7
    v_lshl_add_u32 v7, v2, 10, v7
L_p15_recurren:
    ds_read_b32 v2, v1 offset:0
    s_waitcnt lgkmcnt(0)
    v_readfirstlane_b32 s56, v2
    s_cmp_ge_i32 s56, 44
    s_cbranch_scc1 L_q15_recurren
    s_sleep 1
    s_sub_u32 s28, s28, 1
    s_cmp_gt_i32 s28, 0
    s_cbranch_scc1 L_p15_recurren
L_q15_recurren:
    ds_read_b64 v[148:149], v6 offset:192
    ds_read_b64_tr_b16 v[128:129], v8 offset:12288
    ds_read_b64_tr_b16 v[130:131], v8 offset:12320
    ds_read_b64_tr_b16 v[132:133], v8 offset:12352
    ds_read_b64_tr_b16 v[134:135], v8 offset:12384
    ds_read_b128 v[136:139], v5 offset:0
    ds_read_b64_tr_b16 v[80:81], v7 offset:0
    ds_read_b64_tr_b16 v[82:83], v7 offset:512
    ds_read_b64_tr_b16 v[84:85], v7 offset:32
    ds_read_b64_tr_b16 v[86:87], v7 offset:544
    s_waitcnt lgkmcnt(11)
    ds_read_b64_tr_b16 v[88:89], v7 offset:64
    ds_read_b64_tr_b16 v[90:91], v7 offset:576
    ds_read_b64_tr_b16 v[92:93], v7 offset:96
    ds_read_b64_tr_b16 v[94:95], v7 offset:608
    s_waitcnt lgkmcnt(9)
    v_mfma_f32_16x16x16_bf16 v[32:35], v[148:149], v[128:129], 0
    v_mfma_f32_16x16x16_bf16 v[36:39], v[148:149], v[130:131], 0
    v_mfma_f32_16x16x16_bf16 v[40:43], v[148:149], v[132:133], 0
    v_mfma_f32_16x16x16_bf16 v[44:47], v[148:149], v[134:135], 0
    ds_read_b128 v[140:143], v5 offset:64
    ds_read_b64_tr_b16 v[96:97], v7 offset:4096
    ds_read_b64_tr_b16 v[98:99], v7 offset:4608
    ds_read_b64_tr_b16 v[100:101], v7 offset:4128
    ds_read_b64_tr_b16 v[102:103], v7 offset:4640
    s_waitcnt lgkmcnt(11)
    ds_read_b64_tr_b16 v[104:105], v7 offset:4160
    ds_read_b64_tr_b16 v[106:107], v7 offset:4672
    ds_read_b64_tr_b16 v[108:109], v7 offset:4192
    ds_read_b64_tr_b16 v[110:111], v7 offset:4704
    s_waitcnt lgkmcnt(9)
    v_mfma_f32_16x16x32_bf16 v[32:35], v[136:139], v[80:83], v[32:35]
    v_mfma_f32_16x16x32_bf16 v[36:39], v[136:139], v[84:87], v[36:39]
    v_mfma_f32_16x16x32_bf16 v[40:43], v[136:139], v[88:91], v[40:43]
    v_mfma_f32_16x16x32_bf16 v[44:47], v[136:139], v[92:95], v[44:47]
    ds_read_b128 v[144:147], v5 offset:128
    ds_read_b64_tr_b16 v[112:113], v7 offset:8192
    ds_read_b64_tr_b16 v[114:115], v7 offset:8704
    ds_read_b64_tr_b16 v[116:117], v7 offset:8224
    ds_read_b64_tr_b16 v[118:119], v7 offset:8736
    s_waitcnt lgkmcnt(11)
    ds_read_b64_tr_b16 v[120:121], v7 offset:8256
    ds_read_b64_tr_b16 v[122:123], v7 offset:8768
    ds_read_b64_tr_b16 v[124:125], v7 offset:8288
    ds_read_b64_tr_b16 v[126:127], v7 offset:8800
    s_waitcnt lgkmcnt(9)
    v_mfma_f32_16x16x32_bf16 v[32:35], v[140:143], v[96:99], v[32:35]
    v_mfma_f32_16x16x32_bf16 v[36:39], v[140:143], v[100:103], v[36:39]
    v_mfma_f32_16x16x32_bf16 v[40:43], v[140:143], v[104:107], v[40:43]
    v_mfma_f32_16x16x32_bf16 v[44:47], v[140:143], v[108:111], v[44:47]
    s_waitcnt lgkmcnt(0)
    v_mfma_f32_16x16x32_bf16 v[32:35], v[144:147], v[112:115], v[32:35]
    v_mfma_f32_16x16x32_bf16 v[36:39], v[144:147], v[116:119], v[36:39]
    v_mfma_f32_16x16x32_bf16 v[40:43], v[144:147], v[120:123], v[40:43]
    v_mfma_f32_16x16x32_bf16 v[44:47], v[144:147], v[124:127], v[44:47]
    s_and_b32 s58, s2, 3
    s_mul_i32 s58, s58, 0x3800
    s_lshr_b32 s59, s2, 2
    s_lshl_b32 s59, s59, 8
    s_add_u32 s58, s58, s59
    s_add_u32 s58, s58, 0x40000
    v_cmp_gt_u32 vcc, 16, v0
    v_lshrrev_b32 v48, 4, v0
    v_mul_u32_u24 v2, 0xe000, v48
    v_and_b32 v48, 15, v0
    v_lshl_add_u32 v2, v48, 4, v2
    v_cndmask_b32 v48, v33, v32, vcc
    v_cndmask_b32 v49, v37, v36, vcc
    v_cndmask_b32 v50, v41, v40, vcc
    v_cndmask_b32 v51, v45, v44, vcc
    v_add_u32 v48, 0x200, v48
    v_add_u32 v49, 0x200, v49
    v_add_u32 v50, 0x200, v50
    v_add_u32 v51, 0x200, v51
    v_bfi_b32 v48, s61, v24, v48
    v_bfi_b32 v49, s61, v25, v49
    v_bfi_b32 v50, s61, v26, v50
    v_bfi_b32 v51, s61, v27, v51
    s_mov_b32 exec_lo, 0xffffffff
    s_mov_b32 exec_hi, 0x0
    buffer_store_dwordx4 v[48:51], v2, s[36:39], s58 offen sc1
    s_mov_b64 exec, -1
L_nof1_recurren:
    s_cmp_lt_u32 s2, 200
    s_cbranch_scc1 L_noffn_recurren
    v_mov_b32 v2, 0x1111
    ds_write_b32 v1, v2 offset:264
    s_sub_u32 s60, s2, 200
    s_mul_i32 s99, s60, 2
    v_lshrrev_b32 v2, 5, v0
    v_mul_u32_u24 v4, 0xe000, v2
    v_lshlrev_b32 v5, 8, v2
    v_bfe_u32 v2, v0, 4, 1
    v_mul_u32_u24 v2, 0x1c00, v2
    v_add_u32 v4, v2, v4
    v_and_b32 v2, 15, v0
    v_lshl_add_u32 v4, v2, 4, v4
    v_lshl_add_u32 v5, v2, 2, v5
    v_add_u32 v5, 0x23800, v5
    v_lshrrev_b32 v2, 4, v0
    v_lshlrev_b32 v6, 4, v2
    v_bfe_u32 v2, v0, 3, 1
    v_lshl_add_u32 v6, v2, 8, v6
    v_add_u32 v6, 0x23800, v6
    s_and_b32 s29, s99, 3
    s_lshl_b32 s29, s29, 6
    v_add_u32 v6, s29, v6
    s_lshr_b32 s29, s99, 2
    s_lshl_b32 s29, s29, 8
    s_add_u32 s29, s29, 0x40000
    s_add_u32 s30, s29, 0x3800
    s_add_u32 s31, s29, 0x7000
    s_add_u32 s63, s29, 0xa800
L_p16_recurren:
    ds_read_b32 v2, v1 offset:0
    s_waitcnt lgkmcnt(0)
    v_readfirstlane_b32 s56, v2
    s_cmp_ge_i32 s56, 120
    s_cbranch_scc1 L_q16_recurren
    s_sleep 1
    s_sub_u32 s28, s28, 1
    s_cmp_gt_i32 s28, 0
    s_cbranch_scc1 L_p16_recurren
L_q16_recurren:
    s_mov_b64 s[4:5], -1
    s_mov_b64 s[6:7], -1
    s_mov_b64 s[8:9], -1
    s_mov_b64 s[10:11], -1
L_gf_recurren:
    s_mov_b64 exec, s[4:5]
    buffer_load_dwordx4 v[32:35], v4, s[36:39], s29 offen sc1
    s_mov_b64 exec, s[6:7]
    buffer_load_dwordx4 v[36:39], v4, s[36:39], s30 offen sc1
    s_mov_b64 exec, s[8:9]
    buffer_load_dwordx4 v[40:43], v4, s[36:39], s31 offen sc1
    s_mov_b64 exec, s[10:11]
    buffer_load_dwordx4 v[44:47], v4, s[36:39], s63 offen sc1
    s_waitcnt vmcnt(0)
L_cf_recurren:
    s_mov_b64 exec, s[4:5]
    v_xor_b32 v32, v32, v24
    v_xor_b32 v33, v33, v25
    v_xor_b32 v34, v34, v26
    v_xor_b32 v35, v35, v27
    v_or3_b32 v2, v32, v33, v34
    v_bitop3_b32 v2, v2, v35, s61 bitop3:0xa8
    v_cmp_ne_u32 s[4:5], 0, v2
    s_mov_b64 exec, s[6:7]
    v_xor_b32 v36, v36, v24
    v_xor_b32 v37, v37, v25
    v_xor_b32 v38, v38, v26
    v_xor_b32 v39, v39, v27
    v_or3_b32 v2, v36, v37, v38
    v_bitop3_b32 v2, v2, v39, s61 bitop3:0xa8
    v_cmp_ne_u32 s[6:7], 0, v2
    s_mov_b64 exec, s[8:9]
    v_xor_b32 v40, v40, v24
    v_xor_b32 v41, v41, v25
    v_xor_b32 v42, v42, v26
    v_xor_b32 v43, v43, v27
    v_or3_b32 v2, v40, v41, v42
    v_bitop3_b32 v2, v2, v43, s61 bitop3:0xa8
    v_cmp_ne_u32 s[8:9], 0, v2
    s_mov_b64 exec, s[10:11]
    v_xor_b32 v44, v44, v24
    v_xor_b32 v45, v45, v25
    v_xor_b32 v46, v46, v26
    v_xor_b32 v47, v47, v27
    v_or3_b32 v2, v44, v45, v46
    v_bitop3_b32 v2, v2, v47, s61 bitop3:0xa8
    v_cmp_ne_u32 s[10:11], 0, v2
    s_mov_b64 exec, -1
    s_or_b64 vcc, s[4:5], s[6:7]
    s_or_b64 vcc, vcc, s[8:9]
    s_or_b64 vcc, vcc, s[10:11]
    s_cbranch_scc0 L_xf_recurren
    s_sleep 16
    s_sub_u32 s28, s28, 1
    s_cmp_gt_i32 s28, 0
    s_cbranch_scc1 L_gf_recurren
L_xf_recurren:
    v_add_f32 v32, v32, v36
    v_add_f32 v40, v40, v44
    v_add_f32 v33, v33, v37
    v_add_f32 v41, v41, v45
    v_add_f32 v34, v34, v38
    v_add_f32 v42, v42, v46
    v_add_f32 v35, v35, v39
    v_add_f32 v43, v43, v47
    v_add_f32 v48, v32, v40
    v_add_f32 v52, v32, v40
    v_add_f32 v49, v33, v41
    v_add_f32 v53, v33, v41
    v_add_f32 v50, v34, v42
    v_add_f32 v54, v34, v42
    v_add_f32 v51, v35, v43
    v_add_f32 v55, v35, v43
    s_nop 1
    v_permlane16_swap_b32 v48, v52
    v_permlane16_swap_b32 v49, v53
    v_permlane16_swap_b32 v50, v54
    v_permlane16_swap_b32 v51, v55
    v_cvt_pk_bf16_f32 v48, v48, v48
    v_and_b32 v48, 0xffff0000, v48
    v_cvt_pk_bf16_f32 v52, v52, v52
    v_and_b32 v52, 0xffff0000, v52
    v_mul_f32 v2, 0xbfb8aa3b, v48
    v_exp_f32 v2, v2
    s_nop 0
    v_add_f32 v2, 1.0, v2
    v_rcp_f32 v2, v2
    s_nop 0
    v_mul_f32 v48, v48, v2
    v_cvt_pk_bf16_f32 v48, v48, v48
    v_and_b32 v48, 0xffff0000, v48
    v_mul_f32 v48, v48, v52
    v_cvt_pk_bf16_f32 v49, v49, v49
    v_and_b32 v49, 0xffff0000, v49
    v_cvt_pk_bf16_f32 v53, v53, v53
    v_and_b32 v53, 0xffff0000, v53
    v_mul_f32 v2, 0xbfb8aa3b, v49
    v_exp_f32 v2, v2
    s_nop 0
    v_add_f32 v2, 1.0, v2
    v_rcp_f32 v2, v2
    s_nop 0
    v_mul_f32 v49, v49, v2
    v_cvt_pk_bf16_f32 v49, v49, v49
    v_and_b32 v49, 0xffff0000, v49
    v_mul_f32 v49, v49, v53
    v_cvt_pk_bf16_f32 v50, v50, v50
    v_and_b32 v50, 0xffff0000, v50
    v_cvt_pk_bf16_f32 v54, v54, v54
    v_and_b32 v54, 0xffff0000, v54
    v_mul_f32 v2, 0xbfb8aa3b, v50
    v_exp_f32 v2, v2
    s_nop 0
    v_add_f32 v2, 1.0, v2
    v_rcp_f32 v2, v2
    s_nop 0
    v_mul_f32 v50, v50, v2
    v_cvt_pk_bf16_f32 v50, v50, v50
    v_and_b32 v50, 0xffff0000, v50
    v_mul_f32 v50, v50, v54
    v_cvt_pk_bf16_f32 v51, v51, v51
    v_and_b32 v51, 0xffff0000, v51
    v_cvt_pk_bf16_f32 v55, v55, v55
    v_and_b32 v55, 0xffff0000, v55
    v_mul_f32 v2, 0xbfb8aa3b, v51
    v_exp_f32 v2, v2
    s_nop 0
    v_add_f32 v2, 1.0, v2
    v_rcp_f32 v2, v2
    s_nop 0
    v_mul_f32 v51, v51, v2
    v_cvt_pk_bf16_f32 v51, v51, v51
    v_and_b32 v51, 0xffff0000, v51
    v_mul_f32 v51, v51, v55
    s_mov_b32 exec_lo, 0xffff
    s_mov_b32 exec_hi, 0xffff
    ds_write_b32 v5, v48 offset:0
    ds_write_b32 v5, v49 offset:64
    ds_write_b32 v5, v50 offset:128
    ds_write_b32 v5, v51 offset:192
    s_mov_b64 exec, -1
    s_waitcnt lgkmcnt(0)
    ds_read_b128 v[64:67], v6 offset:0
    s_waitcnt vmcnt(0) lgkmcnt(0)
    v_cvt_pk_bf16_f32 v64, v64, v64
    v_cvt_pk_bf16_f32 v65, v65, v65
    v_cvt_pk_bf16_f32 v66, v66, v66
    v_cvt_pk_bf16_f32 v67, v67, v67
    v_and_b32 v48, v64, v16
    v_and_b32 v49, v64, v17
    v_and_b32 v50, v64, v18
    v_and_b32 v51, v64, v19
    v_and_b32 v52, v65, v16
    v_and_b32 v53, v65, v17
    v_and_b32 v54, v65, v18
    v_and_b32 v55, v65, v19
    v_and_b32 v56, v66, v16
    v_and_b32 v57, v66, v17
    v_and_b32 v58, v66, v18
    v_and_b32 v59, v66, v19
    v_and_b32 v60, v67, v16
    v_and_b32 v61, v67, v17
    v_and_b32 v62, v67, v18
    v_and_b32 v63, v67, v19
    s_nop 1
    v_mfma_f32_16x16x32_bf16 v[152:155], v[48:51], a[0:3], 0
    v_mfma_f32_16x16x32_bf16 v[156:159], v[48:51], a[4:7], 0
    v_mfma_f32_16x16x32_bf16 v[160:163], v[48:51], a[8:11], 0
    v_mfma_f32_16x16x32_bf16 v[164:167], v[48:51], a[12:15], 0
    v_mfma_f32_16x16x32_bf16 v[152:155], v[52:55], a[16:19], v[152:155]
    v_mfma_f32_16x16x32_bf16 v[156:159], v[52:55], a[20:23], v[156:159]
    v_mfma_f32_16x16x32_bf16 v[160:163], v[52:55], a[24:27], v[160:163]
    v_mfma_f32_16x16x32_bf16 v[164:167], v[52:55], a[28:31], v[164:167]
    v_mfma_f32_16x16x32_bf16 v[152:155], v[56:59], a[32:35], v[152:155]
    v_mfma_f32_16x16x32_bf16 v[156:159], v[56:59], a[36:39], v[156:159]
    v_mfma_f32_16x16x32_bf16 v[160:163], v[56:59], a[40:43], v[160:163]
    v_mfma_f32_16x16x32_bf16 v[164:167], v[56:59], a[44:47], v[164:167]
    v_mfma_f32_16x16x32_bf16 v[152:155], v[60:63], a[48:51], v[152:155]
    v_mfma_f32_16x16x32_bf16 v[156:159], v[60:63], a[52:55], v[156:159]
    v_mfma_f32_16x16x32_bf16 v[160:163], v[60:63], a[56:59], v[160:163]
    v_mfma_f32_16x16x32_bf16 v[164:167], v[60:63], a[60:63], v[164:167]
    ds_read_b128 v[64:67], v6 offset:64
    s_waitcnt vmcnt(0) lgkmcnt(0)
    v_cvt_pk_bf16_f32 v64, v64, v64
    v_cvt_pk_bf16_f32 v65, v65, v65
    v_cvt_pk_bf16_f32 v66, v66, v66
    v_cvt_pk_bf16_f32 v67, v67, v67
    v_and_b32 v48, v64, v16
    v_and_b32 v49, v64, v17
    v_and_b32 v50, v64, v18
    v_and_b32 v51, v64, v19
    v_and_b32 v52, v65, v16
    v_and_b32 v53, v65, v17
    v_and_b32 v54, v65, v18
    v_and_b32 v55, v65, v19
    v_and_b32 v56, v66, v16
    v_and_b32 v57, v66, v17
    v_and_b32 v58, v66, v18
    v_and_b32 v59, v66, v19
    v_and_b32 v60, v67, v16
    v_and_b32 v61, v67, v17
    v_and_b32 v62, v67, v18
    v_and_b32 v63, v67, v19
    s_nop 1
    v_mfma_f32_16x16x32_bf16 v[152:155], v[48:51], a[64:67], v[152:155]
    v_mfma_f32_16x16x32_bf16 v[156:159], v[48:51], a[68:71], v[156:159]
    v_mfma_f32_16x16x32_bf16 v[160:163], v[48:51], a[72:75], v[160:163]
    v_mfma_f32_16x16x32_bf16 v[164:167], v[48:51], a[76:79], v[164:167]
    v_mfma_f32_16x16x32_bf16 v[152:155], v[52:55], a[80:83], v[152:155]
    v_mfma_f32_16x16x32_bf16 v[156:159], v[52:55], a[84:87], v[156:159]
    v_mfma_f32_16x16x32_bf16 v[160:163], v[52:55], a[88:91], v[160:163]
    v_mfma_f32_16x16x32_bf16 v[164:167], v[52:55], a[92:95], v[164:167]
    v_mfma_f32_16x16x32_bf16 v[152:155], v[56:59], a[96:99], v[152:155]
    v_mfma_f32_16x16x32_bf16 v[156:159], v[56:59], a[100:103], v[156:159]
    v_mfma_f32_16x16x32_bf16 v[160:163], v[56:59], a[104:107], v[160:163]
    v_mfma_f32_16x16x32_bf16 v[164:167], v[56:59], a[108:111], v[164:167]
    v_mfma_f32_16x16x32_bf16 v[152:155], v[60:63], a[112:115], v[152:155]
    v_mfma_f32_16x16x32_bf16 v[156:159], v[60:63], a[116:119], v[156:159]
    v_mfma_f32_16x16x32_bf16 v[160:163], v[60:63], a[120:123], v[160:163]
    v_mfma_f32_16x16x32_bf16 v[164:167], v[60:63], a[124:127], v[164:167]
L_noffn_recurren:
    s_lshl_b32 s58, s57, 3
    v_bfe_u32 v15, v0, 2, 2
    v_lshlrev_b32 v15, 1, v15
    buffer_load_ushort v14, v15, s[32:35], s58 offen
    s_and_b32 s49, s2, 7
    s_mul_i32 s49, s49, 0x1100
    s_add_u32 s49, s49, 0x60000
    s_lshr_b32 s58, s2, 3
    s_lshl_b32 s58, s58, 2
    v_mov_b32 v5, s58
    v_and_b32 v6, 31, v0
    v_lshlrev_b32 v6, 2, v6
    v_lshlrev_b32 v7, 16, v28
    ds_read_b32 v2, v1 offset:0
    s_waitcnt lgkmcnt(0)
    v_readfirstlane_b32 s50, v2
L_agm_recurren:
    ds_read_b32 v2, v1 offset:0
    s_waitcnt lgkmcnt(0)
    v_readfirstlane_b32 s56, v2
    v_or_b32 v2, v7, v2
    s_mov_b64 exec, 1
    buffer_store_dword v2, v5, s[36:39], s49 offen
    s_mov_b64 exec, -1
    buffer_load_dword v3, v6, s[36:39], s49 offen sc1
    s_add_u32 s51, s56, s50
    s_mov_b32 s50, s56
    s_waitcnt vmcnt(0)
    v_xor_b32 v3, v3, v7
    v_cmp_gt_u32 vcc, 0x10000, v3
    v_lshlrev_b32 v3, 1, v3
    v_subrev_u32 v3, s51, v3
    v_cndmask_b32 v3, 0, v3, vcc
    s_nop 1
    v_add_u32_dpp v3, v3, v3 row_ror:8 row_mask:0xf bank_mask:0xf
    s_nop 1
    v_add_u32_dpp v3, v3, v3 row_ror:4 row_mask:0xf bank_mask:0xf
    s_nop 1
    v_add_u32_dpp v3, v3, v3 row_ror:2 row_mask:0xf bank_mask:0xf
    s_nop 1
    v_add_u32_dpp v3, v3, v3 row_ror:1 row_mask:0xf bank_mask:0xf
    s_nop 1
    v_readlane_b32 s58, v3, 0
    v_readlane_b32 s59, v3, 16
    s_add_u32 s58, s58, s59
    s_mov_b32 s59, 0xeeee
    s_cmp_ge_i32 s58, -1024
    s_cselect_b32 s59, 0x4444, s59
    s_cmp_ge_i32 s58, -384
    s_cselect_b32 s59, 0x0, s59
    s_cmp_ge_i32 s58, 384
    s_cselect_b32 s59, 0x1010, s59
    s_cmp_ge_i32 s58, 1024
    s_cselect_b32 s59, 0x1111, s59
    v_mov_b32 v2, s59
    ds_write_b32 v1, v2 offset:264
    s_cmp_ge_i32 s56, 1436
    s_cbranch_scc1 L_agxm_recurren
    s_sleep 48
    s_sub_u32 s28, s28, 1
    s_cmp_gt_i32 s28, 0
    s_cbranch_scc1 L_agm_recurren
L_agxm_recurren:
    s_bfe_u32 s58, s98, 0x30004
    s_lshl_b32 s58, s58, 11
    s_lshr_b32 s59, s98, 7
    s_lshl_b32 s59, s59, 9
    s_add_u32 s58, s58, s59
    s_add_u32 s58, s58, 0x4000
    v_lshrrev_b32 v2, 5, v0
    v_lshlrev_b32 v13, 10, v2
    v_lshl_add_u32 v4, v2, 3, v1
    v_and_b32 v2, 31, v0
    v_lshl_add_u32 v13, v2, 4, v13
    s_mov_b32 s62, 0x3db8aa3b
    s_mov_b64 s[4:5], -1
L_gm_recurren:
    s_mov_b64 exec, s[4:5]
    buffer_load_dwordx4 v[32:35], v13, s[36:39], s58 offen sc1
    s_waitcnt vmcnt(0)
L_cm_recurren:
    s_mov_b64 exec, s[4:5]
    v_xor_b32 v32, v32, v24
    v_xor_b32 v33, v33, v25
    v_xor_b32 v34, v34, v26
    v_xor_b32 v35, v35, v27
    v_or3_b32 v2, v32, v33, v34
    v_bitop3_b32 v2, v2, v35, s61 bitop3:0xa8
    v_cmp_ne_u32 s[4:5], 0, v2
    s_mov_b64 exec, -1
    s_or_b64 vcc, s[4:5], s[4:5]
    s_cbranch_scc0 L_xm_recurren
    s_sleep 16
    s_sub_u32 s28, s28, 1
    s_cmp_gt_i32 s28, 0
    s_cbranch_scc1 L_gm_recurren
L_xm_recurren:
    v_mov_b32 v34, v32
    s_nop 1
    v_max_f32_dpp v34, v34, v34 row_ror:8 row_mask:0xf bank_mask:0xf
    s_nop 1
    v_max_f32_dpp v34, v34, v34 row_ror:4 row_mask:0xf bank_mask:0xf
    s_nop 1
    v_max_f32_dpp v34, v34, v34 row_ror:2 row_mask:0xf bank_mask:0xf
    s_nop 1
    v_max_f32_dpp v34, v34, v34 row_ror:1 row_mask:0xf bank_mask:0xf
    s_nop 1
    v_mov_b32 v2, v34
    s_nop 1
    v_permlane16_swap_b32 v34, v2
    v_max_f32 v34, v34, v2
    v_sub_f32 v32, v32, v34
    v_mul_f32 v32, s62, v32
    v_exp_f32 v32, v32
    s_nop 0
    v_mul_f32 v35, v32, v33
    s_nop 1
    v_add_f32_dpp v35, v35, v35 row_ror:8 row_mask:0xf bank_mask:0xf
    s_nop 1
    v_add_f32_dpp v35, v35, v35 row_ror:4 row_mask:0xf bank_mask:0xf
    s_nop 1
    v_add_f32_dpp v35, v35, v35 row_ror:2 row_mask:0xf bank_mask:0xf
    s_nop 1
    v_add_f32_dpp v35, v35, v35 row_ror:1 row_mask:0xf bank_mask:0xf
    s_nop 1
    v_mov_b32 v2, v35
    s_nop 1
    v_permlane16_swap_b32 v35, v2
    v_add_f32 v35, v35, v2
    v_rcp_f32 v35, v35
    v_mov_b32 v2, 1
    ds_write_b64 v4, v[34:35] offset:288
    s_waitcnt lgkmcnt(0)
    ds_write_b32 v1, v2 offset:284
    s_mul_i32 s29, s48, 28672
    s_bfe_u32 s59, s2, 0x10003
    s_mul_i32 s58, s59, 448
    s_add_u32 s29, s29, s58
    s_add_u32 s30, s29, 14336
    s_mov_b64 exec, 1
    buffer_load_dword v80, v9, s[44:47], s29 offen nt
    s_mov_b64 exec, -1
L_agb_recurren:
    ds_read_b32 v2, v1 offset:0
    s_waitcnt lgkmcnt(0)
    v_readfirstlane_b32 s56, v2
    v_or_b32 v2, v7, v2
    s_mov_b64 exec, 1
    buffer_store_dword v2, v5, s[36:39], s49 offen
    s_mov_b64 exec, -1
    buffer_load_dword v3, v6, s[36:39], s49 offen sc1
    s_add_u32 s51, s56, s50
    s_mov_b32 s50, s56
    s_waitcnt vmcnt(0)
    v_xor_b32 v3, v3, v7
    v_cmp_gt_u32 vcc, 0x10000, v3
    v_lshlrev_b32 v3, 1, v3
    v_subrev_u32 v3, s51, v3
    v_cndmask_b32 v3, 0, v3, vcc
    s_nop 1
    v_add_u32_dpp v3, v3, v3 row_ror:8 row_mask:0xf bank_mask:0xf
    s_nop 1
    v_add_u32_dpp v3, v3, v3 row_ror:4 row_mask:0xf bank_mask:0xf
    s_nop 1
    v_add_u32_dpp v3, v3, v3 row_ror:2 row_mask:0xf bank_mask:0xf
    s_nop 1
    v_add_u32_dpp v3, v3, v3 row_ror:1 row_mask:0xf bank_mask:0xf
    s_nop 1
    v_readlane_b32 s58, v3, 0
    v_readlane_b32 s59, v3, 16
    s_add_u32 s58, s58, s59
    s_mov_b32 s59, 0xeeee
    s_cmp_ge_i32 s58, -1024
    s_cselect_b32 s59, 0x4444, s59
    s_cmp_ge_i32 s58, -384
    s_cselect_b32 s59, 0x0, s59
    s_cmp_ge_i32 s58, 384
    s_cselect_b32 s59, 0x1010, s59
    s_cmp_ge_i32 s58, 1024
    s_cselect_b32 s59, 0x1111, s59
    v_mov_b32 v2, s59
    ds_write_b32 v1, v2 offset:264
    s_cmp_ge_i32 s56, 1964
    s_cbranch_scc1 L_agxb_recurren
    s_sleep 48
    s_sub_u32 s28, s28, 1
    s_cmp_gt_i32 s28, 0
    s_cbranch_scc1 L_agb_recurren
L_agxb_recurren:
    s_cmp_lt_u32 s2, 200
    s_cbranch_scc1 L_nfs_recurren
L_p17_recurren:
    ds_read_b32 v2, v1 offset:0
    s_waitcnt lgkmcnt(0)
    v_readfirstlane_b32 s56, v2
    s_cmp_ge_i32 s56, 2012
    s_cbranch_scc1 L_q17_recurren
    s_sleep 1
    s_sub_u32 s28, s28, 1
    s_cmp_gt_i32 s28, 0
    s_cbranch_scc1 L_p17_recurren
L_q17_recurren:
    s_sub_u32 s59, s2, 200
    s_mul_i32 s59, s59, 0xe80
    s_add_u32 s59, s59, 0x280000
    v_bfi_b32 v152, s61, v24, v152
    v_bfi_b32 v153, s61, v25, v153
    v_bfi_b32 v154, s61, v26, v154
    v_bfi_b32 v155, s61, v27, v155
    buffer_store_dwordx4 v[152:155], v10, s[36:39], s59 offen offset:0 sc1
    v_bfi_b32 v156, s61, v24, v156
    v_bfi_b32 v157, s61, v25, v157
    v_bfi_b32 v158, s61, v26, v158
    v_bfi_b32 v159, s61, v27, v159
    buffer_store_dwordx4 v[156:159], v10, s[36:39], s59 offen offset:512 sc1
    v_bfi_b32 v160, s61, v24, v160
    v_bfi_b32 v161, s61, v25, v161
    v_bfi_b32 v162, s61, v26, v162
    v_bfi_b32 v163, s61, v27, v163
    buffer_store_dwordx4 v[160:163], v10, s[36:39], s59 offen offset:1024 sc1
    v_bfi_b32 v164, s61, v24, v164
    v_bfi_b32 v165, s61, v25, v165
    v_bfi_b32 v166, s61, v26, v166
    v_bfi_b32 v167, s61, v27, v167
    s_mov_b32 exec_lo, 0xff00ff
    s_mov_b32 exec_hi, 0xff00ff
    buffer_store_dwordx4 v[164:167], v10, s[36:39], s59 offen offset:1536 sc1
    s_mov_b64 exec, -1
L_nfs_recurren:
    v_lshrrev_b32 v2, 7, v10
    v_mul_u32_u24 v2, 0x4080, v2
    v_and_b32 v10, 127, v10
    v_add_u32 v10, v2, v10
    s_lshr_b32 s63, s57, 3
    s_mul_i32 s63, s63, 0x4080
    s_and_b32 s60, s57, 7
    s_lshl_b32 s60, s60, 4
    s_add_u32 s60, s60, s63
    s_add_u32 s60, s60, 0x200000
    s_add_u32 s63, s60, 0x2000
    s_bfe_u32 s59, s2, 0x10003
    s_mul_i32 s99, s59, 0x1c380
    s_lshl_b32 s59, s48, 7
    s_add_u32 s99, s99, s59
    s_add_u32 s99, s99, 0x200000
    s_mul_i32 s58, s48, 0x1080
    s_add_u32 s58, s58, 0xc0000
    s_lshl_b32 s62, s57, 4
    s_add_u32 s62, s62, 0x280000
    v_mul_u32_u24 v4, 0xe80, v0
    v_mov_b32 v64, 0
    v_mov_b32 v65, 0
    v_mov_b32 v66, 0
    v_mov_b32 v67, 0
    s_mov_b32 s12, 0xffffffff
    s_mov_b32 s13, 0xffffff
    s_cmp_ge_u32 s2, 224
    s_cselect_b64 s[12:13], 0, s[12:13]
    v_and_b32 v5, 31, v0
    v_lshlrev_b32 v5, 2, v5
    s_mov_b32 s31, 24
L_p18_recurren:
    ds_read_b32 v2, v1 offset:0
    s_waitcnt lgkmcnt(0)
    v_readfirstlane_b32 s56, v2
    s_cmp_ge_i32 s56, 2036
    s_cbranch_scc1 L_q18_recurren
    s_sleep 1
    s_sub_u32 s28, s28, 1
    s_cmp_gt_i32 s28, 0
    s_cbranch_scc1 L_p18_recurren
L_q18_recurren:
    buffer_load_dwordx4 v[80:83], v9, s[44:47], s29 offen offset:0 nt
    buffer_load_dwordx4 v[88:91], v9, s[44:47], s29 offen offset:896 nt
    buffer_load_dwordx4 v[96:99], v9, s[44:47], s29 offen offset:1792 nt
    buffer_load_dwordx4 v[104:107], v9, s[44:47], s29 offen offset:2688 nt
    buffer_load_dwordx4 v[112:115], v9, s[44:47], s30 offen offset:0 nt
    buffer_load_dwordx4 v[120:123], v9, s[44:47], s30 offen offset:896 nt
    buffer_load_dwordx4 v[128:131], v9, s[44:47], s30 offen offset:1792 nt
    buffer_load_dwordx4 v[136:139], v9, s[44:47], s30 offen offset:2688 nt
    s_mov_b32 exec_lo, 0xfff0fff
    s_mov_b32 exec_hi, 0xfff0fff
    buffer_load_dwordx4 v[84:87], v9, s[44:47], s29 offen offset:256 nt
    buffer_load_dwordx4 v[92:95], v9, s[44:47], s29 offen offset:1152 nt
    buffer_load_dwordx4 v[100:103], v9, s[44:47], s29 offen offset:2048 nt
    buffer_load_dwordx4 v[108:111], v9, s[44:47], s29 offen offset:2944 nt
    buffer_load_dwordx4 v[116:119], v9, s[44:47], s30 offen offset:256 nt
    buffer_load_dwordx4 v[124:127], v9, s[44:47], s30 offen offset:1152 nt
    buffer_load_dwordx4 v[132:135], v9, s[44:47], s30 offen offset:2048 nt
    buffer_load_dwordx4 v[140:143], v9, s[44:47], s30 offen offset:2944 nt
    s_mov_b64 exec, -1
L_p19_recurren:
    ds_read_b32 v2, v1 offset:0
    s_waitcnt lgkmcnt(0)
    v_readfirstlane_b32 s56, v2
    s_cmp_ge_i32 s56, 2076
    s_cbranch_scc1 L_q19_recurren
    s_sleep 1
    s_sub_u32 s28, s28, 1
    s_cmp_gt_i32 s28, 0
    s_cbranch_scc1 L_p19_recurren
L_q19_recurren:
L_hw_recurren:
    buffer_load_dword v2, v5, s[36:39], s49 offen offset:512 sc1
    s_sub_u32 s31, s31, 1
    s_waitcnt vmcnt(0)
    v_cmp_ne_u32 vcc, v2, v28
    s_cbranch_vccz L_hwx_recurren
    s_cmp_gt_i32 s31, 0
    s_cbranch_scc1 L_hw_recurren
L_hwx_recurren:
    s_mov_b64 s[4:5], -1
    s_mov_b64 s[6:7], -1
    s_mov_b64 s[8:9], -1
    s_mov_b64 s[10:11], -1
L_gh_recurren:
    s_mov_b64 exec, s[4:5]
    buffer_load_dwordx4 v[48:51], v12, s[36:39], s58 offen offset:0 sc1
    s_mov_b64 exec, s[6:7]
    buffer_load_dwordx4 v[52:55], v12, s[36:39], s58 offen offset:64 sc1
    s_mov_b64 exec, s[8:9]
    buffer_load_dwordx4 v[56:59], v12, s[36:39], s58 offen offset:2048 sc1
    s_mov_b64 exec, s[10:11]
    buffer_load_dwordx4 v[60:63], v12, s[36:39], s58 offen offset:2112 sc1
    s_waitcnt vmcnt(0)
L_ch_recurren:
    s_mov_b64 exec, s[4:5]
    v_xor_b32 v48, v48, v24
    v_xor_b32 v49, v49, v25
    v_xor_b32 v50, v50, v26
    v_xor_b32 v51, v51, v27
    v_or3_b32 v2, v48, v49, v50
    v_bitop3_b32 v2, v2, v51, s61 bitop3:0xa8
    v_cmp_ne_u32 s[4:5], 0, v2
    s_mov_b64 exec, s[6:7]
    v_xor_b32 v52, v52, v24
    v_xor_b32 v53, v53, v25
    v_xor_b32 v54, v54, v26
    v_xor_b32 v55, v55, v27
    v_or3_b32 v2, v52, v53, v54
    v_bitop3_b32 v2, v2, v55, s61 bitop3:0xa8
    v_cmp_ne_u32 s[6:7], 0, v2
    s_mov_b64 exec, s[8:9]
    v_xor_b32 v56, v56, v24
    v_xor_b32 v57, v57, v25
    v_xor_b32 v58, v58, v26
    v_xor_b32 v59, v59, v27
    v_or3_b32 v2, v56, v57, v58
    v_bitop3_b32 v2, v2, v59, s61 bitop3:0xa8
    v_cmp_ne_u32 s[8:9], 0, v2
    s_mov_b64 exec, s[10:11]
    v_xor_b32 v60, v60, v24
    v_xor_b32 v61, v61, v25
    v_xor_b32 v62, v62, v26
    v_xor_b32 v63, v63, v27
    v_or3_b32 v2, v60, v61, v62
    v_bitop3_b32 v2, v2, v63, s61 bitop3:0xa8
    v_cmp_ne_u32 s[10:11], 0, v2
    s_mov_b64 exec, -1
    s_or_b64 vcc, s[4:5], s[6:7]
    s_or_b64 vcc, vcc, s[8:9]
    s_or_b64 vcc, vcc, s[10:11]
    s_cbranch_scc0 L_xh_recurren
    s_sub_u32 s28, s28, 1
    s_cmp_gt_i32 s28, 0
    s_cbranch_scc1 L_gh_recurren
L_xh_recurren:
    s_mov_b64 exec, s[12:13]
    buffer_load_dwordx4 v[64:67], v4, s[36:39], s62 offen sc1
    s_mov_b64 exec, -1
    v_add_f32_dpp v48, v48, v48 row_ror:8 row_mask:0xf bank_mask:0x3
    v_add_f32_dpp v49, v49, v49 row_ror:8 row_mask:0xf bank_mask:0x3
    v_add_f32_dpp v50, v50, v50 row_ror:8 row_mask:0xf bank_mask:0x3
    v_add_f32_dpp v51, v51, v51 row_ror:8 row_mask:0xf bank_mask:0x3
    v_add_f32_dpp v52, v52, v52 row_ror:8 row_mask:0xf bank_mask:0x3
    v_add_f32_dpp v53, v53, v53 row_ror:8 row_mask:0xf bank_mask:0x3
    v_add_f32_dpp v54, v54, v54 row_ror:8 row_mask:0xf bank_mask:0x3
    v_add_f32_dpp v55, v55, v55 row_ror:8 row_mask:0xf bank_mask:0x3
    v_add_f32_dpp v48, v56, v56 row_ror:8 row_mask:0xf bank_mask:0xc
    v_add_f32_dpp v49, v57, v57 row_ror:8 row_mask:0xf bank_mask:0xc
    v_add_f32_dpp v50, v58, v58 row_ror:8 row_mask:0xf bank_mask:0xc
    v_add_f32_dpp v51, v59, v59 row_ror:8 row_mask:0xf bank_mask:0xc
    v_add_f32_dpp v52, v60, v60 row_ror:8 row_mask:0xf bank_mask:0xc
    v_add_f32_dpp v53, v61, v61 row_ror:8 row_mask:0xf bank_mask:0xc
    v_add_f32_dpp v54, v62, v62 row_ror:8 row_mask:0xf bank_mask:0xc
    v_add_f32_dpp v55, v63, v63 row_ror:8 row_mask:0xf bank_mask:0xc
    v_add_f32_dpp v48, v48, v48 row_half_mirror row_mask:0xf bank_mask:0xf
    v_add_f32_dpp v49, v49, v49 row_half_mirror row_mask:0xf bank_mask:0xf
    v_add_f32_dpp v50, v50, v50 row_half_mirror row_mask:0xf bank_mask:0xf
    v_add_f32_dpp v51, v51, v51 row_half_mirror row_mask:0xf bank_mask:0xf
    v_add_f32_dpp v52, v52, v52 row_half_mirror row_mask:0xf bank_mask:0xf
    v_add_f32_dpp v53, v53, v53 row_half_mirror row_mask:0xf bank_mask:0xf
    v_add_f32_dpp v54, v54, v54 row_half_mirror row_mask:0xf bank_mask:0xf
    v_add_f32_dpp v55, v55, v55 row_half_mirror row_mask:0xf bank_mask:0xf
    v_add_f32_dpp v48, v48, v48 quad_perm:[2,3,0,1] row_mask:0xf bank_mask:0xf
    v_add_f32_dpp v49, v49, v49 quad_perm:[2,3,0,1] row_mask:0xf bank_mask:0xf
    v_add_f32_dpp v50, v50, v50 quad_perm:[2,3,0,1] row_mask:0xf bank_mask:0xf
    v_add_f32_dpp v51, v51, v51 quad_perm:[2,3,0,1] row_mask:0xf bank_mask:0xf
    v_add_f32_dpp v52, v52, v52 quad_perm:[2,3,0,1] row_mask:0xf bank_mask:0xf
    v_add_f32_dpp v53, v53, v53 quad_perm:[2,3,0,1] row_mask:0xf bank_mask:0xf
    v_add_f32_dpp v54, v54, v54 quad_perm:[2,3,0,1] row_mask:0xf bank_mask:0xf
    v_add_f32_dpp v55, v55, v55 quad_perm:[2,3,0,1] row_mask:0xf bank_mask:0xf
    v_add_f32_dpp v48, v48, v48 quad_perm:[1,0,3,2] row_mask:0xf bank_mask:0xf
    v_add_f32_dpp v49, v49, v49 quad_perm:[1,0,3,2] row_mask:0xf bank_mask:0xf
    v_add_f32_dpp v50, v50, v50 quad_perm:[1,0,3,2] row_mask:0xf bank_mask:0xf
    v_add_f32_dpp v51, v51, v51 quad_perm:[1,0,3,2] row_mask:0xf bank_mask:0xf
    v_add_f32_dpp v52, v52, v52 quad_perm:[1,0,3,2] row_mask:0xf bank_mask:0xf
    v_add_f32_dpp v53, v53, v53 quad_perm:[1,0,3,2] row_mask:0xf bank_mask:0xf
    v_add_f32_dpp v54, v54, v54 quad_perm:[1,0,3,2] row_mask:0xf bank_mask:0xf
    v_add_f32_dpp v55, v55, v55 quad_perm:[1,0,3,2] row_mask:0xf bank_mask:0xf
    v_cvt_pk_bf16_f32 v48, v48, v48
    v_cvt_pk_bf16_f32 v49, v49, v49
    v_cvt_pk_bf16_f32 v50, v50, v50
    v_cvt_pk_bf16_f32 v51, v51, v51
    v_cvt_pk_bf16_f32 v52, v52, v52
    v_cvt_pk_bf16_f32 v53, v53, v53
    v_cvt_pk_bf16_f32 v54, v54, v54
    v_cvt_pk_bf16_f32 v55, v55, v55
    v_and_b32 v56, v48, v16
    v_and_b32 v57, v48, v17
    v_and_b32 v58, v48, v18
    v_and_b32 v59, v48, v19
    v_and_b32 v60, v49, v16
    v_and_b32 v61, v49, v17
    v_and_b32 v62, v49, v18
    v_and_b32 v63, v49, v19
    v_mfma_f32_16x16x32_bf16 v[32:35], v[56:59], v[80:83], 0
    v_mfma_f32_16x16x32_bf16 v[36:39], v[56:59], v[84:87], 0
    v_and_b32 v40, v50, v16
    v_and_b32 v41, v50, v17
    v_and_b32 v42, v50, v18
    v_and_b32 v43, v50, v19
    v_mfma_f32_16x16x32_bf16 v[32:35], v[60:63], v[88:91], v[32:35]
    v_mfma_f32_16x16x32_bf16 v[36:39], v[60:63], v[92:95], v[36:39]
    v_and_b32 v44, v51, v16
    v_and_b32 v45, v51, v17
    v_and_b32 v46, v51, v18
    v_and_b32 v47, v51, v19
    v_mfma_f32_16x16x32_bf16 v[32:35], v[40:43], v[96:99], v[32:35]
    v_mfma_f32_16x16x32_bf16 v[36:39], v[40:43], v[100:103], v[36:39]
    v_and_b32 v56, v52, v16
    v_and_b32 v57, v52, v17
    v_and_b32 v58, v52, v18
    v_and_b32 v59, v52, v19
    v_mfma_f32_16x16x32_bf16 v[32:35], v[44:47], v[104:107], v[32:35]
    v_mfma_f32_16x16x32_bf16 v[36:39], v[44:47], v[108:111], v[36:39]
    v_and_b32 v60, v53, v16
    v_and_b32 v61, v53, v17
    v_and_b32 v62, v53, v18
    v_and_b32 v63, v53, v19
    v_mfma_f32_16x16x32_bf16 v[32:35], v[56:59], v[112:115], v[32:35]
    v_mfma_f32_16x16x32_bf16 v[36:39], v[56:59], v[116:119], v[36:39]
    v_and_b32 v40, v54, v16
    v_and_b32 v41, v54, v17
    v_and_b32 v42, v54, v18
    v_and_b32 v43, v54, v19
    v_mfma_f32_16x16x32_bf16 v[32:35], v[60:63], v[120:123], v[32:35]
    v_mfma_f32_16x16x32_bf16 v[36:39], v[60:63], v[124:127], v[36:39]
    v_and_b32 v44, v55, v16
    v_and_b32 v45, v55, v17
    v_and_b32 v46, v55, v18
    v_and_b32 v47, v55, v19
    v_mfma_f32_16x16x32_bf16 v[32:35], v[40:43], v[128:131], v[32:35]
    v_mfma_f32_16x16x32_bf16 v[36:39], v[40:43], v[132:135], v[36:39]
    v_mfma_f32_16x16x32_bf16 v[32:35], v[44:47], v[136:139], v[32:35]
    v_mfma_f32_16x16x32_bf16 v[36:39], v[44:47], v[140:143], v[36:39]
    s_add_u32 s59, s99, 0x10200
    s_nop 5
    v_bfi_b32 v32, s61, v24, v32
    v_bfi_b32 v33, s61, v25, v33
    v_bfi_b32 v34, s61, v26, v34
    v_bfi_b32 v35, s61, v27, v35
    buffer_store_dwordx4 v[32:35], v10, s[36:39], s99 offen sc1
    v_bfi_b32 v36, s61, v24, v36
    v_bfi_b32 v37, s61, v25, v37
    v_bfi_b32 v38, s61, v26, v38
    v_bfi_b32 v39, s61, v27, v39
    s_mov_b32 exec_lo, 0xfff0fff
    s_mov_b32 exec_hi, 0xfff0fff
    buffer_store_dwordx4 v[36:39], v10, s[36:39], s59 offen sc1
    s_mov_b64 exec, -1
    s_waitcnt vmcnt(2)
    s_branch L_cg_recurren
L_gg_recurren:
    s_mov_b64 exec, s[12:13]
    buffer_load_dwordx4 v[64:67], v4, s[36:39], s62 offen sc1
    s_waitcnt vmcnt(0)
L_cg_recurren:
    s_mov_b64 exec, s[12:13]
    v_xor_b32 v64, v64, v24
    v_xor_b32 v65, v65, v25
    v_xor_b32 v66, v66, v26
    v_xor_b32 v67, v67, v27
    v_or3_b32 v2, v64, v65, v66
    v_bitop3_b32 v2, v2, v67, s61 bitop3:0xa8
    v_cmp_ne_u32 s[12:13], 0, v2
    s_mov_b64 exec, -1
    s_or_b64 vcc, s[12:13], s[12:13]
    s_cbranch_scc0 L_xg_recurren
    s_sub_u32 s28, s28, 1
    s_cmp_gt_i32 s28, 0
    s_cbranch_scc1 L_gg_recurren
L_xg_recurren:
    s_nop 0
    v_add_f32_dpp v64, v64, v64 row_ror:8 row_mask:0xf bank_mask:0x3
    v_add_f32_dpp v65, v65, v65 row_ror:8 row_mask:0xf bank_mask:0x3
    s_nop 0
    v_add_f32_dpp v64, v66, v66 row_ror:8 row_mask:0xf bank_mask:0xc
    v_add_f32_dpp v65, v67, v67 row_ror:8 row_mask:0xf bank_mask:0xc
    s_nop 0
    v_add_f32_dpp v64, v64, v64 row_shl:4 row_mask:0xf bank_mask:0x5
    s_nop 1
    v_add_f32_dpp v64, v65, v65 row_shr:4 row_mask:0xf bank_mask:0xa
    s_nop 1
    v_add_f32_dpp v64, v64, v64 quad_perm:[2,3,0,1] row_mask:0xf bank_mask:0xf
    s_nop 1
    v_add_f32_dpp v64, v64, v64 quad_perm:[1,0,3,2] row_mask:0xf bank_mask:0xf
    v_mov_b32 v65, v64
    s_nop 1
    v_permlane16_swap_b32 v64, v65
    v_add_f32 v64, v64, v65
    v_mov_b32 v65, v64
    s_nop 1
    v_permlane32_swap_b32 v64, v65
    v_add_f32 v64, v64, v65
    v_cvt_pk_bf16_f32 v64, v64, v64
    v_and_b32 v64, 0xffff0000, v64
    v_mul_f32 v2, 0xbfb8aa3b, v64
    v_exp_f32 v2, v2
    s_nop 0
    v_add_f32 v2, 1.0, v2
    v_rcp_f32 v2, v2
    s_nop 0
    v_mul_f32 v20, v64, v2
    v_cvt_pk_bf16_f32 v20, v20, v20
    v_and_b32 v20, 0xffff0000, v20
    v_lshlrev_b32 v14, 16, v14
    s_cmp_ge_u32 s2, 224
    s_cbranch_scc1 L_fin_recurren
    s_waitcnt vmcnt(0)
    s_mov_b64 s[4:5], -1
    s_mov_b64 s[6:7], -1
L_gs_recurren:
    s_mov_b64 exec, s[4:5]
    buffer_load_dwordx4 v[48:51], v11, s[36:39], s60 offen sc1
    s_mov_b64 exec, s[6:7]
    buffer_load_dwordx4 v[52:55], v11, s[36:39], s63 offen sc1
    s_waitcnt vmcnt(0)
L_cs_recurren:
    s_mov_b64 exec, s[4:5]
    v_xor_b32 v48, v48, v24
    v_xor_b32 v49, v49, v25
    v_xor_b32 v50, v50, v26
    v_xor_b32 v51, v51, v27
    v_or3_b32 v2, v48, v49, v50
    v_bitop3_b32 v2, v2, v51, s61 bitop3:0xa8
    v_cmp_ne_u32 s[4:5], 0, v2
    s_mov_b64 exec, s[6:7]
    v_xor_b32 v52, v52, v24
    v_xor_b32 v53, v53, v25
    v_xor_b32 v54, v54, v26
    v_xor_b32 v55, v55, v27
    v_or3_b32 v2, v52, v53, v54
    v_bitop3_b32 v2, v2, v55, s61 bitop3:0xa8
    v_cmp_ne_u32 s[6:7], 0, v2
    s_mov_b64 exec, -1
    s_or_b64 vcc, s[4:5], s[6:7]
    s_cbranch_scc0 L_xs_recurren
    s_sub_u32 s28, s28, 1
    s_cmp_gt_i32 s28, 0
    s_cbranch_scc1 L_gs_recurren
L_xs_recurren:
    v_add_f32 v48, v48, v52
    v_add_f32 v49, v49, v53
    v_add_f32 v50, v50, v54
    v_add_f32 v51, v51, v55
    s_nop 0
    v_add_f32_dpp v48, v48, v48 row_ror:8 row_mask:0xf bank_mask:0x3
    v_add_f32_dpp v49, v49, v49 row_ror:8 row_mask:0xf bank_mask:0x3
    s_nop 0
    v_add_f32_dpp v48, v50, v50 row_ror:8 row_mask:0xf bank_mask:0xc
    v_add_f32_dpp v49, v51, v51 row_ror:8 row_mask:0xf bank_mask:0xc
    s_nop 0
    v_add_f32_dpp v48, v48, v48 row_shl:4 row_mask:0xf bank_mask:0x5
    s_nop 1
    v_add_f32_dpp v48, v49, v49 row_shr:4 row_mask:0xf bank_mask:0xa
    s_nop 1
    v_add_f32_dpp v48, v48, v48 quad_perm:[2,3,0,1] row_mask:0xf bank_mask:0xf
    s_nop 1
    v_add_f32_dpp v48, v48, v48 quad_perm:[1,0,3,2] row_mask:0xf bank_mask:0xf
    v_mov_b32 v49, v48
    s_nop 1
    v_permlane16_swap_b32 v48, v49
    v_add_f32 v48, v48, v49
    v_mov_b32 v49, v48
    s_nop 1
    v_permlane32_swap_b32 v48, v49
    v_add_f32 v48, v48, v49
    v_cvt_pk_bf16_f32 v48, v48, v48
    v_and_b32 v48, 0xffff0000, v48
    v_mul_f32 v48, v48, v20
    v_cvt_pk_bf16_f32 v48, v48, v48
    v_and_b32 v48, 0xffff0000, v48
    v_add_f32 v48, v48, v14
    s_lshl_b32 s58, s57, 3
    v_cvt_pk_bf16_f32 v48, v48, v48
    s_mov_b32 exec_lo, 0x1111
    s_mov_b32 exec_hi, 0x0
    buffer_store_short v48, v15, s[52:55], s58 offen
    s_cmp_lg_u32 s2, 0
    s_cbranch_scc1 L_fin_recurren
    s_mov_b64 exec, 1
    buffer_store_dword v28, v15, s[36:39], 0 offen offset:0 sc1
L_fin_recurren:
L_end_recurren:
    s_endpgm
.section .rodata,"a"
.p2align 6
.amdhsa_kernel recurrent_scan__gqa_block_cached__swiglu_ffn__decode_kernel
  .amdhsa_next_free_vgpr 296
  .amdhsa_next_free_sgpr 102
  .amdhsa_accum_offset 168
  .amdhsa_group_segment_fixed_size 0
  .amdhsa_kernarg_size 96
  .amdhsa_user_sgpr_count 2
  .amdhsa_user_sgpr_kernarg_segment_ptr 1
  .amdhsa_system_sgpr_workgroup_id_x 1
  .amdhsa_float_denorm_mode_32 3
.end_amdhsa_kernel
```
